```python
import torch

def _softmax(x, axis=-1):
    return torch.softmax(x, dim=axis)
def _gelu(x):
    return torch.nn.functional.gelu(x, approximate="tanh")
def _silu(x):
    return torch.nn.functional.silu(x)
def _sigmoid(x):
    return torch.sigmoid(x)
def _layernorm(x, axis=-1, eps=1e-5):
    m = x.mean(dim=axis, keepdim=True)
    v = x.var(dim=axis, keepdim=True, unbiased=False)
    return (x - m) / torch.sqrt(v + eps)
def _scatter_add(tgt, idx, src, axis=0):
    return tgt.clone().index_add_(axis, idx, src)
def _segment_sum(src, seg, n):
    out = torch.zeros((n,) + src.shape[1:], dtype=src.dtype)
    return out.index_add_(0, seg, src)
def _pad(x, pw):
    flat = tuple(v for pair in reversed(pw) for v in pair)
    return torch.nn.functional.pad(x, flat)

kernel_name = 'concat_heads__spectral_fnet__spectral_fnet__prompt'

def setup_inputs():

    _w = (lambda a: (lambda t: t.to(torch.bfloat16) if t.is_floating_point() else t)(torch.as_tensor(a)))
    def _A_setup():
        B, S, D = 1, 2048, 448
        ns = torch.arange(S)[:, None] * torch.arange(S)[None, :]
        nd = torch.arange(D)[:, None] * torch.arange(D)[None, :]
        Ws_re = torch.cos(-2.0 * torch.pi * ns / S).to(float)
        Ws_im = torch.sin(-2.0 * torch.pi * ns / S).to(float)
        Wd_re = torch.cos(-2.0 * torch.pi * nd / D).to(float)
        Wd_im = torch.sin(-2.0 * torch.pi * nd / D).to(float)
        return {
            "x": _w((lambda *s: torch.randn(*s, dtype=torch.bfloat16) * 0.05)(B, S, D)),
            "dft_seq_re": _w(Ws_re),
            "dft_seq_im": _w(Ws_im),
            "dft_hid_re": _w(Wd_re),
            "dft_hid_im": _w(Wd_im),
        }
    _A_in = _A_setup()

    def _B_setup():
        B, S, D = 1, 2048, 448
        ns = torch.arange(S)[:, None] * torch.arange(S)[None, :]
        nd = torch.arange(D)[:, None] * torch.arange(D)[None, :]
        Ws_re = torch.cos(-2.0 * torch.pi * ns / S).to(float)
        Ws_im = torch.sin(-2.0 * torch.pi * ns / S).to(float)
        Wd_re = torch.cos(-2.0 * torch.pi * nd / D).to(float)
        Wd_im = torch.sin(-2.0 * torch.pi * nd / D).to(float)
        return {
            "x": _w((lambda *s: torch.randn(*s, dtype=torch.bfloat16) * 0.05)(B, S, D)),
            "dft_seq_re": _w(Ws_re),
            "dft_seq_im": _w(Ws_im),
            "dft_hid_re": _w(Wd_re),
            "dft_hid_im": _w(Wd_im),
        }
    _B_in = _B_setup()

    return {
        "A_x": _A_in["x"],
        "A_dft_seq_re": _A_in["dft_seq_re"],
        "A_dft_seq_im": _A_in["dft_seq_im"],
        "A_dft_hid_re": _A_in["dft_hid_re"],
        "A_dft_hid_im": _A_in["dft_hid_im"],
        "B_x": _B_in["x"],
        "B_dft_seq_re": _B_in["dft_seq_re"],
        "B_dft_seq_im": _B_in["dft_seq_im"],
        "B_dft_hid_re": _B_in["dft_hid_re"],
        "B_dft_hid_im": _B_in["dft_hid_im"],
    }

def reference(A_x, A_dft_seq_re, A_dft_seq_im, A_dft_hid_re, A_dft_hid_im, B_x, B_dft_seq_re, B_dft_seq_im, B_dft_hid_re, B_dft_hid_im):
    def _A_ref(x, dft_seq_re, dft_seq_im, dft_hid_re, dft_hid_im):
        a = torch.einsum("bsd,ed->bse", x, dft_hid_re)
        b = torch.einsum("bsd,ed->bse", x, dft_hid_im)
        y = torch.einsum("ts,bse->bte", dft_seq_re, a) - torch.einsum("ts,bse->bte", dft_seq_im, b)
        return y

    def _B_ref(x, dft_seq_re, dft_seq_im, dft_hid_re, dft_hid_im):
        a = torch.einsum("bsd,ed->bse", x, dft_hid_re)
        b = torch.einsum("bsd,ed->bse", x, dft_hid_im)
        y = torch.einsum("ts,bse->bte", dft_seq_re, a) - torch.einsum("ts,bse->bte", dft_seq_im, b)
        return y

    a = _A_ref(A_x, A_dft_seq_re, A_dft_seq_im, A_dft_hid_re, A_dft_hid_im)
    b = _B_ref(B_x, B_dft_seq_re, B_dft_seq_im, B_dft_hid_re, B_dft_hid_im)
    return torch.concatenate([a, b], axis=-1)
```

```asm
; @launch grid=(258,1,1) block=(256,1,1) lds=37888
.amdgcn_target "amdgcn-amd-amdhsa--gfx950"
.text
.globl concat_heads__spectral_fnet__spectral_fnet__prompt_kernel
.p2align 8
.type concat_heads__spectral_fnet__spectral_fnet__prompt_kernel,@function
concat_heads__spectral_fnet__spectral_fnet__prompt_kernel:
    s_bfe_u32 s5, s2, 0x10003
    s_mul_i32 s7, s5, 40
    s_load_dwordx2 s[8:9], s[0:1], s7
    s_load_dwordx2 s[12:13], s[0:1], 96
    s_load_dwordx2 s[44:45], s[0:1], 80
    s_cmp_ge_u32 s2, 258
    s_cbranch_scc1 L_END
    s_getpc_b64 s[16:17]
L_PC:
    v_lshlrev_b32 v4, 7, v0
    s_cmp_ge_u32 s2, 32
    s_cbranch_scc1 L_NOCI
    global_load_dword v59, v4, s[16:17]
L_NOCI:
    s_and_b32 s33, s2, 7
    s_sub_u32 s3, 16, s33
    s_cmp_eq_u32 s33, 0
    s_cselect_b32 s3, 8, s3
    s_bfe_u32 s36, s2, 0x10004
    s_cselect_b32 s3, s3, s33
    s_bfe_u32 s6, s2, 0x30005
    s_lshl_b32 s23, s6, 8
    s_add_u32 s23, s23, s3
    s_mul_i32 s23, s23, 896
    v_lshrrev_b32 v9, 4, v0
    v_mul_u32_u24 v9, 14336, v9
    v_and_b32 v8, 15, v0
    v_min_u32 v8, 6, v8
    v_lshl_add_u32 v9, v8, 7, v9
    s_mov_b32 s10, 1835008
    s_mov_b32 s11, 0x20000
    s_waitcnt lgkmcnt(0)
    buffer_load_dword v57, v9, s[8:11], s23 offen
    s_and_b32 s20, s2, 1
    s_cmp_ge_u32 s2, 256
    s_cselect_b32 s5, s20, s5
    s_lshl_b32 s38, s5, 7
    s_add_u32 s38, s38, 2359296
    s_load_dwordx2 s[34:35], s[12:13], s38
    v_lshrrev_b32 v6, 6, v0
    v_and_b32 v0, 63, v0
    v_readfirstlane_b32 s4, v6
    s_sub_u32 s32, 16, s3
    s_and_b32 s32, s32, 15
    v_lshlrev_b32 v1, 4, v0
    v_lshrrev_b32 v6, 4, v0
    v_bfe_u32 v7, v0, 2, 2
    v_mul_u32_u24 v2, 14336, v6
    v_mul_u32_u24 v7, 114688, v7
    v_lshrrev_b32 v3, 3, v0
    v_and_b32 v3, 2, v3
    v_xor_b32 v4, v3, v0
    v_and_b32 v4, 3, v4
    v_lshlrev_b32 v4, 4, v4
    v_add3_u32 v2, v2, v7, v4
    s_lshl_b32 s39, s4, 12
    s_add_u32 m0, s39, 2048
    s_mul_i32 s20, s4, 458752
    s_and_b32 s37, s6, 1
    s_mul_i32 s21, s6, 7
    s_sub_u32 s21, s21, s37
    s_lshl_b32 s21, s21, 3
    s_mul_i32 s24, s3, 896
    s_mul_i32 s26, s32, 896
    s_add_u32 s24, s24, s20
    s_add_u32 s26, s26, s20
    s_add_u32 s24, s24, s21
    s_sub_u32 s26, s26, s21
    s_add_u32 s25, s24, 56320
    s_add_u32 s27, s26, 57152
    s_add_u32 s26, s26, 832
    s_mov_b32 s14, 2359296
    s_mov_b32 s15, 0x20000
    s_cmp_ge_u32 s2, 256
    s_cbranch_scc1 L_SKIP1
    buffer_load_dwordx4 v2, s[8:11], s26 offen lds
    buffer_load_dwordx4 v2, s[8:11], s27 offen offset:1024 lds
    s_mov_b32 m0, s39
    s_nop 0
    buffer_load_dwordx4 v2, s[8:11], s24 offen lds
    buffer_load_dwordx4 v2, s[8:11], s25 offen offset:1024 lds
L_SKIP1:
    s_lshl_b32 s22, s4, 12
    s_mov_b32 s46, 3670016
    s_mov_b32 s47, 0x20000
    s_lshl_b32 s20, s6, 3
    s_add_u32 s33, s33, s20
    s_lshl_b32 s31, s36, 10
    s_add_u32 s31, s31, s33
    s_lshr_b32 s21, 128, s36
    s_cmp_eq_u32 s33, 0
    s_cselect_b32 s31, s21, s31
    s_cselect_b32 s20, 2, 0
    s_add_u32 s36, s20, s36
    s_cmp_ge_u32 s2, 256
    s_cselect_b32 s33, 0, s33
    s_cselect_b32 s36, 4, s36
    s_cselect_b32 s31, 1024, s31
    s_add_u32 s16, s16, K2_TAB-L_PC
    s_addc_u32 s17, s17, 0
    s_add_u32 s40, s16, 8192
    s_addc_u32 s41, s17, 0
    s_lshl_b32 s20, s36, 12
    s_lshl_b32 s21, s4, 10
    s_add_u32 s20, s20, s21
    s_add_u32 s20, s20, 7168
    s_add_u32 s18, s16, s20
    s_addc_u32 s19, s17, 0
    s_lshl_b32 s21, s4, 11
    s_add_u32 s16, s16, s21
    s_addc_u32 s17, s17, 0
    s_mul_i32 s53, s4, 3072
    s_add_u32 s53, s53, 16384
    s_mul_i32 s20, s5, 1179648
    s_mul_i32 s21, s33, 16640
    s_add_u32 s54, s20, s21
    s_lshr_b32 s21, s33, 4
    s_mul_i32 s21, s21, 1024
    s_add_u32 s54, s54, s21
    s_lshl_b32 s21, s4, 9
    s_add_u32 s54, s54, s21
    s_cmp_ge_u32 s2, 256
    s_cbranch_scc1 L_CONS
    v_bfe_u32 v5, v0, 3, 2
    v_mul_u32_u24 v5, 267264, v5
    v_and_b32 v7, 0x70, v1
    v_add_u32 v5, v5, v7
    s_lshl_b32 s21, s4, 2
    s_sub_u32 s22, 14, s21
    s_sub_u32 s21, 16, s21
    s_cmp_eq_u32 s4, 0
    s_cselect_b32 s21, 8, s21
    s_mul_i32 s21, s21, 16640
    s_mul_i32 s22, s22, 16640
    v_lshrrev_b32 v7, 5, v0
    v_mad_u32_u24 v53, v7, s22, v5
    v_mad_u32_u24 v5, v7, s21, v5
    s_mul_i32 s20, s5, 1179648
    s_lshl_b32 s21, s3, 7
    s_add_u32 s20, s20, s21
    s_lshl_b32 s21, s6, 11
    s_add_u32 s20, s20, s21
    s_mul_i32 s21, s4, 33280
    s_add_u32 s28, s20, s21
    s_add_u32 s29, s28, 16640
    s_lshl_b32 s20, s4, 1
    v_bfe_u32 v32, v0, 1, 1
    v_add_u32 v32, s20, v32
    v_and_b32 v33, 1, v0
    v_cmp_eq_u32 vcc, 0, v32
    v_lshlrev_b32 v34, 3, v33
    v_lshlrev_b32 v35, 2, v33
    v_cndmask_b32 v32, v32, v34, vcc
    v_cndmask_b32 v35, v35, 0, vcc
    v_and_b32 v34, 1, v32
    v_cvt_f32_u32 v32, v32
    v_cvt_f32_u32 v35, v35
    v_mul_u32_u24 v34, 0x8000, v34
    v_mul_f32 v32, 0x3d800000, v32
    v_mul_f32 v35, 0x3d800000, v35
    v_lshl_or_b32 v34, v34, 16, v34
    v_mov_b32 v8, 0
    v_mov_b32 v9, 0
    v_mov_b32 v10, 0
    v_mov_b32 v11, 0
    s_mov_b32 exec_lo, 0xf0000f
    s_mov_b32 exec_hi, 0xf0000f00
    v_cos_f32 v36, v35
    v_add_f32 v35, v35, v32
    v_cos_f32 v37, v35
    v_add_f32 v35, v35, v32
    v_cvt_pk_bf16_f32 v8, v36, v37
    v_cos_f32 v36, v35
    v_add_f32 v35, v35, v32
    v_cos_f32 v37, v35
    v_add_f32 v35, v35, v32
    v_cvt_pk_bf16_f32 v9, v36, v37
    v_cos_f32 v36, v35
    v_add_f32 v35, v35, v32
    v_cos_f32 v37, v35
    v_add_f32 v35, v35, v32
    v_cvt_pk_bf16_f32 v10, v36, v37
    v_cos_f32 v36, v35
    v_add_f32 v35, v35, v32
    v_cos_f32 v37, v35
    s_nop 0
    v_cvt_pk_bf16_f32 v11, v36, v37
    s_mov_b64 exec, -1
    v_xor_b32 v12, v34, v8
    v_xor_b32 v13, v34, v9
    v_xor_b32 v14, v34, v10
    v_xor_b32 v15, v34, v11
    v_lshlrev_b32 v38, 3, v0
    v_and_b32 v38, 0x30, v38
    v_and_b32 v39, 0x30, v0
    v_add_u32 v40, s32, v39
    v_add_u32 v39, s3, v39
    v_and_b32 v47, 8, v0
    v_cmp_ne_u32 s[56:57], 0, v47
    v_cvt_f32_u32 v39, v39
    v_cvt_f32_u32 v40, v40
    v_cvt_f32_u32 v48, v33
    v_sub_u32 v45, -16, v38
    v_mul_f32 v39, 0x3a000000, v39
    v_mul_f32 v40, 0x3a000000, v40
    v_cndmask_b32 v45, v38, v45, s[56:57]
    v_mul_f32 v49, 0x3e800000, v48
    v_mul_f32 v50, 0.5, v48
    v_add_u32 v45, s20, v45
    v_add_f32 v43, v49, v50
    v_add_u32 v46, 1, v45
    v_cndmask_b32 v43, v49, v43, s[56:57]
    v_add_f32 v44, v43, v50
    v_mov_b32 v41, v43
    v_mov_b32 v42, v44
    s_cmp_lg_u32 s4, 0
    s_cbranch_scc1 L_REG
    v_cvt_f32_u32 v51, v6
    v_add_u32 v45, v47, v38
    v_and_b32 v56, 14, v0
    v_add_f32 v41, 0x3e800000, v49
    v_cmp_eq_u32 vcc, 0, v56
    v_mul_f32 v51, v51, v50
    v_cndmask_b32 v41, v49, v41, s[56:57]
    s_cmp_eq_u32 s3, 0
    s_cselect_b64 s[58:59], vcc, 0
    v_cndmask_b32 v41, v41, v51, vcc
    v_add_f32 v42, v41, v50
    v_cndmask_b32 v42, v42, v41, s[58:59]
L_REG:
    v_cvt_f32_i32 v45, v45
    v_cvt_f32_i32 v46, v46
    v_mul_f32 v47, 0x3d000000, v45
    v_fma_f32 v50, v45, v39, v41
    v_cos_f32 v36, v50
    v_sin_f32 v37, v50
    v_add_f32 v50, v50, v47
    v_cvt_pk_bf16_f32 v16, v36, v37
    v_cos_f32 v36, v50
    v_sin_f32 v37, v50
    s_nop 0
    v_cvt_pk_bf16_f32 v17, v36, v37
    v_fma_f32 v50, v45, v40, v42
    v_cos_f32 v36, v50
    v_sin_f32 v37, v50
    v_add_f32 v50, v50, v47
    v_cvt_pk_bf16_f32 v18, v36, v37
    v_cos_f32 v36, v50
    v_sin_f32 v37, v50
    s_nop 0
    v_cvt_pk_bf16_f32 v19, v36, v37
    v_mul_f32 v47, 0x3d000000, v46
    v_fma_f32 v50, v46, v39, v43
    v_cos_f32 v36, v50
    v_sin_f32 v37, v50
    v_add_f32 v50, v50, v47
    v_cvt_pk_bf16_f32 v20, v36, v37
    v_cos_f32 v36, v50
    v_sin_f32 v37, v50
    s_nop 0
    v_cvt_pk_bf16_f32 v21, v36, v37
    v_fma_f32 v50, v46, v40, v44
    v_cos_f32 v36, v50
    v_sin_f32 v37, v50
    v_add_f32 v50, v50, v47
    v_cvt_pk_bf16_f32 v22, v36, v37
    v_cos_f32 v36, v50
    v_sin_f32 v37, v50
    s_nop 0
    v_cvt_pk_bf16_f32 v23, v36, v37
    s_cmp_lg_u32 s4, 0
    s_cbranch_scc1 L_REG2
    v_mov_b32 v36, 0xffff
    v_not_b32 v37, v36
    v_cndmask_b32 v36, v36, v37, s[56:57]
    v_and_b32 v16, v36, v16
    v_and_b32 v17, v36, v17
    v_and_b32 v18, v36, v18
    v_and_b32 v19, v36, v19
L_REG2:
    v_and_b32 v36, 15, v0
    v_lshl_add_u32 v37, v6, 2, v36
    v_sub_u32 v38, 28, v37
    v_sub_u32 v37, 12, v37
    v_mov_b32 v41, 0
    v_mov_b32 v42, 0x3f80
    v_cmp_gt_u32 vcc, 4, v38
    v_lshlrev_b32 v38, 4, v38
    v_mov_b32 v30, 0
    v_cndmask_b32 v40, 0, v42, vcc
    v_cmp_gt_u32 vcc, 4, v37
    v_lshlrev_b64 v[24:25], v38, v[40:41]
    v_lshlrev_b32 v37, 4, v37
    v_cndmask_b32 v40, 0, v42, vcc
    s_mul_i32 s21, s37, 0x3f80
    v_lshlrev_b64 v[26:27], v37, v[40:41]
    v_mov_b32 v31, 0
    v_mov_b32 v28, v26
    v_mov_b32 v29, v27
    v_writelane_b32 v26, s21, 48
    v_writelane_b32 v28, s21, 12
    v_lshlrev_b32 v3, 4, v3
    v_and_b32 v4, 3, v0
    v_and_b32 v7, 0x3c0, v1
    s_xor_b32 s21, s37, 1
    v_add_lshl_u32 v48, v4, s21, 3
    v_add_lshl_u32 v49, v4, s37, 3
    v_xor_b32 v48, v48, v3
    v_xor_b32 v3, v49, v3
    v_add_u32 v48, v48, v7
    v_add_u32 v3, v3, v7
    v_xor_b32 v49, 32, v48
    s_mul_i32 s20, s4, 2304
    s_add_u32 s20, s20, 28672
    v_lshrrev_b32 v2, 2, v0
    v_mul_u32_u24 v2, 72, v2
    v_lshl_add_u32 v2, v4, 4, v2
    v_add_u32 v2, s20, v2
    v_xor_b32 v4, 32, v3
    s_lshl_b32 s21, s6, 4
    s_and_b32 s21, s21, 32
    s_add_u32 s22, s20, s21
    s_xor_b32 s21, s21, 32
    s_add_u32 s23, s20, s21
    v_mul_u32_u24 v7, 72, v36
    v_lshl_add_u32 v7, v6, 3, v7
    v_add_u32 v6, s22, v7
    v_add_u32 v7, s23, v7
    s_mul_i32 s30, s37, 0xffff
    s_waitcnt lgkmcnt(0)
    s_or_b32 s34, s34, 0x40000000
    s_or_b32 s35, s35, 0x40004000
    s_add_u32 s34, s34, 0x2b150000
    s_add_u32 s35, s35, 0x1e3739b9
    s_and_b32 s34, s34, 0xbfff0000
    s_and_b32 s35, s35, 0xbfffbfff
    s_mov_b32 s56, 0
    s_mov_b32 s57, 0xffff0000
    v_mov_b32 v54, s34
    s_waitcnt vmcnt(0)
    s_barrier
    ds_read_b64_tr_b16 v[56:57], v48 offset:2048
    ds_read_b64_tr_b16 v[58:59], v48 offset:6144
    ds_read_b64_tr_b16 v[60:61], v48 offset:3072
    ds_read_b64_tr_b16 v[62:63], v48 offset:7168
    ds_read_b64_tr_b16 v[64:65], v49 offset:2048
    ds_read_b64_tr_b16 v[66:67], v49 offset:6144
    ds_read_b64_tr_b16 v[68:69], v49 offset:3072
    ds_read_b64_tr_b16 v[70:71], v49 offset:7168
    s_mov_b32 m0, s53
    ds_read_b64_tr_b16 v[72:73], v48 offset:10240
    ds_read_b64_tr_b16 v[74:75], v48 offset:14336
    global_load_dwordx4 v[144:147], v1, s[40:41]
    ds_read_b64_tr_b16 v[76:77], v48 offset:11264
    ds_read_b64_tr_b16 v[78:79], v48 offset:15360
    s_waitcnt lgkmcnt(8)
    v_mfma_f32_16x16x32_bf16 v[32:35], v[8:11], v[56:59], 0
    global_load_lds_dwordx4 v1, s[16:17]
    ds_read_b64_tr_b16 v[80:81], v49 offset:10240
    v_mfma_f32_16x16x32_bf16 v[36:39], v[8:11], v[60:63], 0
    ds_read_b64_tr_b16 v[82:83], v49 offset:14336
    global_load_lds_dwordx4 v1, s[16:17] offset:1024
    s_waitcnt lgkmcnt(5)
    v_mfma_f32_16x16x32_bf16 v[40:43], v[8:11], v[64:67], 0
    ds_read_b64_tr_b16 v[84:85], v49 offset:11264
    ds_read_b64_tr_b16 v[86:87], v49 offset:15360
    v_mfma_f32_16x16x32_bf16 v[44:47], v[8:11], v[68:71], 0
    global_load_lds_dwordx4 v1, s[18:19] offset:2048
    s_waitcnt lgkmcnt(3)
    v_mfma_f32_16x16x32_bf16 v[32:35], v[12:15], v[72:75], v[32:35]
    ds_read_b64_tr_b16 v[88:89], v3 offset:0
    ds_read_b64_tr_b16 v[90:91], v3 offset:4096
    v_mfma_f32_16x16x32_bf16 v[36:39], v[12:15], v[76:79], v[36:39]
    ds_read_b64_tr_b16 v[92:93], v3 offset:1024
    ds_read_b64_tr_b16 v[94:95], v3 offset:5120
    s_waitcnt lgkmcnt(4)
    v_mfma_f32_16x16x32_bf16 v[40:43], v[12:15], v[80:83], v[40:43]
    ds_read_b64_tr_b16 v[96:97], v4 offset:0
    ds_read_b64_tr_b16 v[98:99], v4 offset:4096
    v_mfma_f32_16x16x32_bf16 v[44:47], v[12:15], v[84:87], v[44:47]
    v_cvt_pk_bf16_f32 v64, v32, v33
    v_cvt_pk_bf16_f32 v66, v34, v35
    v_cvt_pk_bf16_f32 v65, v36, v37
    v_cvt_pk_bf16_f32 v67, v38, v39
    s_waitcnt lgkmcnt(2)
    v_mfma_f32_16x16x32_bf16 v[112:115], v[8:11], v[88:91], 0
    v_cvt_pk_bf16_f32 v68, v40, v41
    v_cvt_pk_bf16_f32 v70, v42, v43
    v_mfma_f32_16x16x16_bf16 v[32:35], v[64:65], v[18:19], 0
    v_cvt_pk_bf16_f32 v69, v44, v45
    v_cvt_pk_bf16_f32 v71, v46, v47
    v_mfma_f32_16x16x16_bf16 v[40:43], v[66:67], v[22:23], 0
    ds_read_b64_tr_b16 v[100:101], v4 offset:1024
    ds_read_b64_tr_b16 v[102:103], v4 offset:5120
    v_mfma_f32_16x16x16_bf16 v[36:39], v[68:69], v[18:19], 0
    ds_read_b64_tr_b16 v[104:105], v3 offset:8192
    ds_read_b64_tr_b16 v[106:107], v3 offset:12288
    v_mfma_f32_16x16x16_bf16 v[44:47], v[70:71], v[22:23], 0
    ds_read_b64_tr_b16 v[108:109], v3 offset:9216
    ds_read_b64_tr_b16 v[110:111], v3 offset:13312
    v_mfma_f32_16x16x32_bf16 v[116:119], v[8:11], v[92:95], 0
    ds_read_b64_tr_b16 v[56:57], v4 offset:8192
    ds_read_b64_tr_b16 v[58:59], v4 offset:12288
    s_waitcnt lgkmcnt(5)
    v_mfma_f32_16x16x32_bf16 v[120:123], v[8:11], v[96:99], 0
    ds_read_b64_tr_b16 v[60:61], v4 offset:9216
    ds_read_b64_tr_b16 v[62:63], v4 offset:13312
    v_mfma_f32_16x16x32_bf16 v[124:127], v[8:11], v[100:103], 0
    v_cvt_pk_bf16_f32 v72, v32, v33
    v_cvt_pk_bf16_f32 v73, v34, v35
    s_waitcnt lgkmcnt(3)
    v_mfma_f32_16x16x32_bf16 v[112:115], v[12:15], v[104:107], v[112:115]
    v_cvt_pk_bf16_f32 v74, v36, v37
    v_cvt_pk_bf16_f32 v75, v38, v39
    v_mfma_f32_16x16x32_bf16 v[116:119], v[12:15], v[108:111], v[116:119]
    v_cvt_pk_bf16_f32 v76, v40, v41
    v_cvt_pk_bf16_f32 v77, v42, v43
    s_waitcnt lgkmcnt(0)
    v_mfma_f32_16x16x32_bf16 v[120:123], v[12:15], v[56:59], v[120:123]
    v_cvt_pk_bf16_f32 v78, v44, v45
    v_cvt_pk_bf16_f32 v79, v46, v47
    v_mfma_f32_16x16x32_bf16 v[124:127], v[12:15], v[60:63], v[124:127]
    v_cvt_pk_bf16_f32 v32, v112, v113
    v_cvt_pk_bf16_f32 v34, v114, v115
    v_mfma_f32_16x16x32_bf16 v[80:83], v[24:27], v[72:75], 0
    v_cvt_pk_bf16_f32 v33, v116, v117
    v_cvt_pk_bf16_f32 v35, v118, v119
    v_mfma_f32_16x16x32_bf16 v[88:91], v[24:27], v[76:79], 0
    v_cvt_pk_bf16_f32 v36, v120, v121
    v_cvt_pk_bf16_f32 v38, v122, v123
    v_mfma_f32_16x16x32_bf16 v[84:87], v[28:31], v[72:75], 0
    v_cvt_pk_bf16_f32 v37, v124, v125
    v_cvt_pk_bf16_f32 v39, v126, v127
    v_mfma_f32_16x16x32_bf16 v[92:95], v[28:31], v[76:79], 0
    s_nop 1
    v_mfma_f32_16x16x16_bf16 v[80:83], v[32:33], v[16:17], v[80:83]
    s_nop 1
    v_mfma_f32_16x16x16_bf16 v[88:91], v[34:35], v[20:21], v[88:91]
    v_cvt_pk_bf16_f32 v50, v84, v84
    v_mfma_f32_16x16x16_bf16 v[188:191], v[36:37], v[16:17], v[84:87]
    v_cvt_pk_bf16_f32 v51, v92, v92
    v_mfma_f32_16x16x16_bf16 v[192:195], v[38:39], v[20:21], v[92:95]
    s_nop 0
    v_cvt_pk_bf16_f32 v96, v80, v81
    v_cvt_pk_bf16_f32 v97, v82, v83
    ds_write_b64 v6, v[96:97] offset:0
    v_cvt_pk_bf16_f32 v100, v88, v89
    v_cvt_pk_bf16_f32 v101, v90, v91
    v_cvt_pk_bf16_f32 v98, v188, v189
    v_cvt_pk_bf16_f32 v99, v190, v191
    v_cvt_pk_bf16_f32 v102, v192, v193
    v_cvt_pk_bf16_f32 v103, v194, v195
    ds_write_b64 v6, v[100:101] offset:1152
    s_mov_b64 exec, s[56:57]
    v_and_or_b32 v98, v50, s30, v54
    v_mov_b32 v99, s35
    v_and_or_b32 v102, v51, s30, v54
    v_mov_b32 v103, s35
    s_mov_b64 exec, -1
    ds_write_b64 v7, v[98:99] offset:0
    ds_read2_b64 v[104:107], v2 offset0:0 offset1:1
    ds_write_b64 v7, v[102:103] offset:1152
    ds_read2_b64 v[108:111], v2 offset0:144 offset1:145
    s_lshl_b32 s20, s4, 8
    s_add_u32 s20, s20, s2
    s_cmp_ge_u32 s20, 1008
    s_waitcnt lgkmcnt(2)
    buffer_store_dwordx4 v[104:107], v5, s[12:15], s28 offen sc1
    s_waitcnt lgkmcnt(0)
    buffer_store_dwordx4 v[108:111], v53, s[12:15], s29 offen sc1
    s_cbranch_scc1 L_HINT
L_P2:
    s_waitcnt vmcnt(0)
    s_barrier
    v_lshrrev_b32 v6, 4, v0
    v_lshlrev_b32 v180, 10, v6
    v_and_b32 v7, 0xc0, v1
    v_add_u32 v180, v180, v7
    v_and_b32 v6, 1, v6
    v_lshl_add_u32 v180, v6, 5, v180
    v_and_b32 v7, 3, v0
    v_lshl_add_u32 v180, v7, 3, v180
    s_lshl_b32 s20, s4, 12
    v_add_u32 v196, s20, v180
    s_add_u32 s20, s20, 4096
    s_and_b32 s20, s20, 0x3000
    v_add_u32 v198, s20, v180
    s_add_u32 s20, s20, 4096
    s_and_b32 s20, s20, 0x3000
    v_add_u32 v200, s20, v180
    s_add_u32 s20, s20, 4096
    s_and_b32 s20, s20, 0x3000
    v_add_u32 v202, s20, v180
    v_xor_b32 v197, 32, v196
    v_xor_b32 v199, 32, v198
    v_xor_b32 v201, 32, v200
    v_xor_b32 v203, 32, v202
    v_lshlrev_b32 v181, 5, v6
    v_lshrrev_b32 v7, 5, v0
    v_mul_u32_u24 v7, 1536, v7
    v_add_u32 v180, v7, v1
    s_add_u32 s64, s54, 3072
    s_add_u32 s65, s54, 6144
    s_add_u32 s66, s54, 9216
    v_and_b32 v182, 31, v0
    v_lshrrev_b32 v6, 5, v0
    v_lshl_add_u32 v6, v182, 1, v6
    v_add_u32 v7, 1, v6
    v_cmp_ne_u32 vcc, 56, v7
    v_mov_b32 v186, 0x40000000
    v_lshlrev_b32 v6, 4, v6
    v_cndmask_b32 v7, 0, v7, vcc
    v_cmp_gt_u32 vcc, 28, v182
    v_sub_u32 v183, 880, v6
    v_and_b32 v187, 1, v7
    v_cndmask_b32 v182, v186, v6, vcc
    v_cndmask_b32 v183, v186, v183, vcc
    v_lshlrev_b32 v7, 1, v7
    v_and_b32 v7, 0x7c, v7
    v_lshl_add_u32 v184, v187, 7, v7
    s_lshl_b32 s22, s4, 12
    s_add_u32 s20, s22, 56
    v_and_b32 v185, 0x3c0, v1
    v_add_u32 v185, s20, v185
    v_lshl_add_u32 v187, v1, 2, s20
    v_sub_u32 v187, v187, v181
    v_and_b32 v6, 0xf0, v1
    v_add_u32 v6, s53, v6
    v_add_u32 v7, 16384, v1
    v_mov_b32 v128, 0
    v_mov_b32 v129, 0
    v_mov_b32 v130, 0
    v_mov_b32 v131, 0
    v_mov_b32 v132, 0
    v_mov_b32 v133, 0
    v_mov_b32 v134, 0
    v_mov_b32 v135, 0
    v_mov_b32 v136, 0
    v_mov_b32 v137, 0
    v_mov_b32 v138, 0
    v_mov_b32 v139, 0
    v_mov_b32 v140, 0
    v_mov_b32 v141, 0
    v_mov_b32 v142, 0
    v_mov_b32 v143, 0
    s_lshl_b32 s21, s4, 8
    s_add_u32 s48, s21, s31
    s_add_u32 s49, s48, 128
    s_cmp_eq_u32 s36, 2
    s_cselect_b32 s21, 1023, -1
    s_and_b32 s49, s49, s21
    s_sub_u32 s50, 2048, s48
    s_sub_u32 s51, 2048, s49
    s_and_b32 s51, s51, 2047
    s_mul_i32 s20, s5, 896
    s_mul_i32 s48, s48, 1792
    s_mul_i32 s49, s49, 1792
    s_mul_i32 s50, s50, 1792
    s_mul_i32 s51, s51, 1792
    s_add_u32 s48, s48, s20
    s_add_u32 s49, s49, s20
    s_add_u32 s50, s50, s20
    s_add_u32 s51, s51, s20
    s_mov_b32 s52, 0xffff
    s_mov_b32 s55, 0x400000
    s_mov_b32 m0, s22
    s_mov_b32 exec_lo, 0xf0000f
    s_mov_b32 exec_hi, 0xf0000f00
    ds_read_b128 v[128:131], v6 offset:2048
    ds_read_b128 v[132:135], v6 offset:2304
    ds_read_b128 v[136:139], v6 offset:2560
    ds_read_b128 v[140:143], v6 offset:2816
    s_mov_b64 exec, -1
    ds_read_b128 v[148:151], v7 offset:0
    ds_read_b128 v[152:155], v7 offset:1024
    ds_read_b128 v[156:159], v7 offset:3072
    ds_read_b128 v[160:163], v7 offset:4096
    ds_read_b128 v[164:167], v7 offset:6144
    ds_read_b128 v[168:171], v7 offset:7168
    ds_read_b128 v[172:175], v7 offset:9216
    ds_read_b128 v[176:179], v7 offset:10240
    s_cmp_ge_u32 s2, 256
    s_cbranch_scc1 L_WAIT
L_POLL0:
    buffer_load_dwordx4 v180, s[12:15], s54 offen offset:0 sc1 lds
    buffer_load_dwordx4 v180, s[12:15], s64 offen offset:1024 sc1 lds
    buffer_load_dwordx4 v180, s[12:15], s65 offen offset:2048 sc1 lds
    buffer_load_dwordx4 v180, s[12:15], s66 offen offset:3072 sc1 lds
L_CHK:
    s_waitcnt vmcnt(0)
    ds_read_b64 v[4:5], v187
    ds_read_b64_tr_b16 v[24:25], v196 offset:0
    ds_read_b64_tr_b16 v[26:27], v196 offset:256
    ds_read_b64_tr_b16 v[28:29], v196 offset:512
    ds_read_b64_tr_b16 v[30:31], v196 offset:768
    ds_read_b64_tr_b16 v[32:33], v197 offset:0
    ds_read_b64_tr_b16 v[34:35], v197 offset:256
    ds_read_b64_tr_b16 v[36:37], v197 offset:512
    ds_read_b64_tr_b16 v[38:39], v197 offset:768
    s_waitcnt lgkmcnt(8)
    v_and_b32 v4, 0xffff0000, v4
    v_cmp_ne_u64 vcc, s[34:35], v[4:5]
    s_cbranch_vccnz L_SLOW
L_GO:
    s_cmp_ge_u32 s2, 256
    s_barrier
    s_cbranch_scc1 L_ONE
    ds_read_b64_tr_b16 v[40:41], v198 offset:0
    ds_read_b64_tr_b16 v[42:43], v198 offset:256
    s_waitcnt lgkmcnt(2)
    v_mfma_f32_16x16x32_bf16 v[8:11], v[128:131], v[24:27], 0
    ds_read_b64_tr_b16 v[44:45], v198 offset:512
    ds_read_b64_tr_b16 v[46:47], v198 offset:768
    v_mfma_f32_16x16x32_bf16 v[12:15], v[128:131], v[28:31], 0
    ds_read_b64_tr_b16 v[48:49], v200 offset:0
    ds_read_b64_tr_b16 v[50:51], v200 offset:256
    v_mfma_f32_16x16x32_bf16 v[16:19], v[128:131], v[32:35], 0
    ds_read_b64_tr_b16 v[52:53], v200 offset:512
    ds_read_b64_tr_b16 v[54:55], v200 offset:768
    v_mfma_f32_16x16x32_bf16 v[20:23], v[128:131], v[36:39], 0
    ds_read_b64_tr_b16 v[56:57], v202 offset:0
    ds_read_b64_tr_b16 v[58:59], v202 offset:256
    s_waitcnt lgkmcnt(5)
    v_mfma_f32_16x16x32_bf16 v[8:11], v[132:135], v[40:43], v[8:11]
    ds_read_b64_tr_b16 v[60:61], v202 offset:512
    ds_read_b64_tr_b16 v[62:63], v202 offset:768
    v_mfma_f32_16x16x32_bf16 v[12:15], v[132:135], v[44:47], v[12:15]
    ds_read_b64_tr_b16 v[64:65], v199 offset:0
    ds_read_b64_tr_b16 v[66:67], v199 offset:256
    s_waitcnt lgkmcnt(5)
    v_mfma_f32_16x16x32_bf16 v[8:11], v[136:139], v[48:51], v[8:11]
    ds_read_b64_tr_b16 v[68:69], v199 offset:512
    ds_read_b64_tr_b16 v[70:71], v199 offset:768
    v_mfma_f32_16x16x32_bf16 v[12:15], v[136:139], v[52:55], v[12:15]
    ds_read_b64_tr_b16 v[72:73], v201 offset:0
    ds_read_b64_tr_b16 v[74:75], v201 offset:256
    s_waitcnt lgkmcnt(5)
    v_mfma_f32_16x16x32_bf16 v[8:11], v[140:143], v[56:59], v[8:11]
    ds_read_b64_tr_b16 v[76:77], v201 offset:512
    ds_read_b64_tr_b16 v[78:79], v201 offset:768
    v_mfma_f32_16x16x32_bf16 v[12:15], v[140:143], v[60:63], v[12:15]
    ds_read_b64_tr_b16 v[80:81], v203 offset:0
    ds_read_b64_tr_b16 v[82:83], v203 offset:256
    s_waitcnt lgkmcnt(5)
    v_mfma_f32_16x16x32_bf16 v[16:19], v[132:135], v[64:67], v[16:19]
    ds_read_b64_tr_b16 v[84:85], v203 offset:512
    ds_read_b64_tr_b16 v[86:87], v203 offset:768
    v_mfma_f32_16x16x32_bf16 v[20:23], v[132:135], v[68:71], v[20:23]
    v_cvt_pk_bf16_f32 v88, v8, v9
    v_cvt_pk_bf16_f32 v90, v10, v11
    s_waitcnt lgkmcnt(3)
    v_mfma_f32_16x16x32_bf16 v[16:19], v[136:139], v[72:75], v[16:19]
    v_cvt_pk_bf16_f32 v89, v12, v13
    v_cvt_pk_bf16_f32 v91, v14, v15
    v_mfma_f32_16x16x32_bf16 v[20:23], v[136:139], v[76:79], v[20:23]
    s_nop 1
    v_mfma_f32_16x16x16_bf16 v[96:99], v[88:89], v[144:145], 0
    v_mfma_f32_16x16x16_bf16 v[100:103], v[88:89], v[146:147], 0
    s_nop 1
    v_mfma_f32_16x16x16_bf16 v[104:107], v[90:91], v[144:145], 0
    s_nop 1
    v_mfma_f32_16x16x16_bf16 v[108:111], v[90:91], v[146:147], 0
    s_nop 1
    s_waitcnt lgkmcnt(0)
    v_mfma_f32_16x16x32_bf16 v[16:19], v[140:143], v[80:83], v[16:19]
    v_fmac_f32 v96, v148, v100
    v_fmac_f32 v97, v149, v101
    v_mfma_f32_16x16x32_bf16 v[20:23], v[140:143], v[84:87], v[20:23]
    v_fmac_f32 v98, v150, v102
    v_fmac_f32 v99, v151, v103
    v_fmac_f32 v100, v152, v96
    v_fmac_f32 v101, v153, v97
    v_fmac_f32 v102, v154, v98
    v_cvt_pk_bf16_f32 v92, v16, v17
    v_fmac_f32 v103, v155, v99
    v_fmac_f32 v96, v148, v100
    v_cvt_pk_bf16_f32 v93, v20, v21
    v_fmac_f32 v97, v149, v101
    v_fmac_f32 v98, v150, v102
    v_mfma_f32_16x16x16_bf16 v[112:115], v[92:93], v[144:145], 0
    v_fmac_f32 v99, v151, v103
    v_cvt_pk_bf16_f32 v8, v96, v97
    v_mfma_f32_16x16x16_bf16 v[116:119], v[92:93], v[146:147], 0
    v_cvt_pk_bf16_f32 v9, v98, v99
    v_cvt_pk_bf16_f32 v10, v100, v101
    v_cvt_pk_bf16_f32 v11, v102, v103
    v_cvt_pk_bf16_f32 v94, v18, v19
    v_cvt_pk_bf16_f32 v95, v22, v23
    v_mfma_f32_16x16x32_bf16 v[64:67], v[8:11], v[164:167], 0
    v_fmac_f32 v104, v148, v108
    v_fmac_f32 v105, v149, v109
    v_mfma_f32_16x16x32_bf16 v[68:71], v[8:11], v[172:175], 0
    v_fmac_f32 v112, v156, v116
    v_fmac_f32 v113, v157, v117
    v_mfma_f32_16x16x16_bf16 v[120:123], v[94:95], v[144:145], 0
    v_fmac_f32 v114, v158, v118
    v_fmac_f32 v115, v159, v119
    v_mfma_f32_16x16x16_bf16 v[124:127], v[94:95], v[146:147], 0
    v_fmac_f32 v116, v160, v112
    v_fmac_f32 v117, v161, v113
    v_fmac_f32 v118, v162, v114
    v_fmac_f32 v119, v163, v115
    v_fmac_f32 v112, v156, v116
    v_fmac_f32 v113, v157, v117
    v_fmac_f32 v114, v158, v118
    v_fmac_f32 v115, v159, v119
    v_cvt_pk_bf16_f32 v56, v112, v113
    v_cvt_pk_bf16_f32 v57, v114, v115
    v_cvt_pk_bf16_f32 v58, v116, v117
    v_cvt_pk_bf16_f32 v59, v118, v119
    v_fmac_f32 v106, v150, v110
    v_fmac_f32 v107, v151, v111
    v_mfma_f32_16x16x32_bf16 v[64:67], v[56:59], v[168:171], v[64:67]
    v_fmac_f32 v108, v152, v104
    v_fmac_f32 v109, v153, v105
    v_mfma_f32_16x16x32_bf16 v[68:71], v[56:59], v[176:179], v[68:71]
    v_fmac_f32 v110, v154, v106
    v_fmac_f32 v111, v155, v107
    v_fmac_f32 v104, v148, v108
    v_fmac_f32 v105, v149, v109
    v_fmac_f32 v106, v150, v110
    v_cvt_pk_bf16_f32 v80, v64, v65
    v_cvt_pk_bf16_f32 v81, v66, v67
    v_fmac_f32 v107, v151, v111
    v_cvt_pk_bf16_f32 v82, v68, v69
    v_cvt_pk_bf16_f32 v83, v70, v71
    v_cvt_pk_bf16_f32 v12, v104, v105
    v_permlane16_swap_b32 v80, v82
    ds_bpermute_b32 v2, v184, v80
    v_permlane16_swap_b32 v81, v83
    buffer_store_dwordx4 v[80:83], v182, s[44:47], s48 offen sc1
    v_bfi_b32 v97, s52, v83, v82
    v_bfi_b32 v98, s52, v82, v81
    v_bfi_b32 v99, s52, v81, v80
    v_cvt_pk_bf16_f32 v13, v106, v107
    v_cvt_pk_bf16_f32 v14, v108, v109
    v_cvt_pk_bf16_f32 v15, v110, v111
    v_fmac_f32 v120, v156, v124
    v_fmac_f32 v121, v157, v125
    v_mfma_f32_16x16x32_bf16 v[72:75], v[12:15], v[164:167], 0
    s_waitcnt lgkmcnt(0)
    v_bfi_b32 v96, s52, v2, v83
    buffer_store_dwordx4 v[96:99], v183, s[44:47], s50 offen sc1
    v_mfma_f32_16x16x32_bf16 v[76:79], v[12:15], v[172:175], 0
    v_fmac_f32 v122, v158, v126
    v_fmac_f32 v123, v159, v127
    v_fmac_f32 v124, v160, v120
    v_fmac_f32 v125, v161, v121
    v_fmac_f32 v126, v162, v122
    v_fmac_f32 v127, v163, v123
    v_fmac_f32 v120, v156, v124
    v_fmac_f32 v121, v157, v125
    v_fmac_f32 v122, v158, v126
    v_fmac_f32 v123, v159, v127
    v_cvt_pk_bf16_f32 v60, v120, v121
    v_cvt_pk_bf16_f32 v61, v122, v123
    v_cvt_pk_bf16_f32 v62, v124, v125
    v_cvt_pk_bf16_f32 v63, v126, v127
    s_nop 1
    v_mfma_f32_16x16x32_bf16 v[72:75], v[60:63], v[168:171], v[72:75]
    s_nop 1
    v_mfma_f32_16x16x32_bf16 v[76:79], v[60:63], v[176:179], v[76:79]
    s_nop 4
    v_cvt_pk_bf16_f32 v84, v72, v73
    v_cvt_pk_bf16_f32 v85, v74, v75
    s_nop 0
    v_cvt_pk_bf16_f32 v86, v76, v77
    v_cvt_pk_bf16_f32 v87, v78, v79
    s_nop 0
    v_permlane16_swap_b32 v84, v86
    ds_bpermute_b32 v3, v184, v84
    v_permlane16_swap_b32 v85, v87
    buffer_store_dwordx4 v[84:87], v182, s[44:47], s49 offen sc1
    v_bfi_b32 v101, s52, v87, v86
    v_bfi_b32 v102, s52, v86, v85
    v_bfi_b32 v103, s52, v85, v84
    s_waitcnt lgkmcnt(0)
    v_bfi_b32 v100, s52, v3, v87
    buffer_store_dwordx4 v[100:103], v183, s[44:47], s51 offen sc1
    s_endpgm
L_SLOW:
    s_sub_u32 s55, s55, 1
    s_cbranch_scc1 L_GO
    ds_read_b64 v[8:9], v185 offset:0
    ds_read_b64 v[10:11], v185 offset:992
    ds_read_b64 v[12:13], v185 offset:2048
    ds_read_b64 v[14:15], v185 offset:3040
    s_waitcnt lgkmcnt(3)
    v_and_b32 v8, 0xffff0000, v8
    v_cmp_ne_u64 s[56:57], s[34:35], v[8:9]
    s_waitcnt lgkmcnt(2)
    v_and_b32 v10, 0xffff0000, v10
    v_cmp_ne_u64 s[58:59], s[34:35], v[10:11]
    s_waitcnt lgkmcnt(1)
    v_and_b32 v12, 0xffff0000, v12
    v_cmp_ne_u64 s[60:61], s[34:35], v[12:13]
    s_waitcnt lgkmcnt(0)
    v_and_b32 v14, 0xffff0000, v14
    v_cmp_ne_u64 s[62:63], s[34:35], v[14:15]
    s_mov_b64 exec, s[56:57]
    s_cbranch_execz L_NO0
    buffer_load_dwordx4 v180, s[12:15], s54 offen offset:0 sc1 lds
L_NO0:
    s_mov_b64 exec, s[58:59]
    s_cbranch_execz L_NO1
    buffer_load_dwordx4 v180, s[12:15], s64 offen offset:1024 sc1 lds
L_NO1:
    s_mov_b64 exec, s[60:61]
    s_cbranch_execz L_NO2
    buffer_load_dwordx4 v180, s[12:15], s65 offen offset:2048 sc1 lds
L_NO2:
    s_mov_b64 exec, s[62:63]
    s_cbranch_execz L_NO3
    buffer_load_dwordx4 v180, s[12:15], s66 offen offset:3072 sc1 lds
L_NO3:
    s_mov_b64 exec, -1
    s_branch L_CHK
L_HINT:
    s_lshl_b32 s20, s2, 7
    s_and_b32 s20, s20, 0x780
    s_add_u32 s20, s20, 2360320
    v_mov_b32 v8, s20
    v_mov_b32 v9, s35
    s_mov_b64 exec, 1
    global_store_dword v8, v9, s[12:13] sc1
    s_mov_b64 exec, -1
    s_branch L_P2
L_CONS:
    s_waitcnt lgkmcnt(0)
    s_or_b32 s34, s34, 0x40000000
    s_or_b32 s35, s35, 0x40004000
    s_add_u32 s34, s34, 0x2b150000
    s_add_u32 s35, s35, 0x1e3739b9
    s_and_b32 s34, s34, 0xbfff0000
    s_and_b32 s35, s35, 0xbfffbfff
    s_mov_b32 m0, s53
    global_load_dwordx4 v[144:147], v1, s[40:41]
    global_load_lds_dwordx4 v1, s[16:17]
    global_load_lds_dwordx4 v1, s[16:17] offset:1024
    global_load_lds_dwordx4 v1, s[18:19] offset:2048
    s_branch L_P2
L_WAIT:
    s_lshl_b32 s20, s5, 10
    s_add_u32 s20, s20, 2360320
    v_lshl_add_u32 v8, v1, 3, s20
    s_mov_b64 exec, 0xff
L_SENT:
    global_load_dword v9, v8, s[12:13] sc1
    s_waitcnt vmcnt(0)
    v_cmp_ne_u32 vcc, s35, v9
    s_nop 0
    s_and_b64 exec, exec, vcc
    s_cbranch_scc0 L_SENT2
    s_sub_u32 s55, s55, 1
    s_cbranch_scc0 L_SENT
L_SENT2:
    s_mov_b64 exec, -1
    s_mov_b32 s55, 0x400000
    s_branch L_POLL0
L_ONE:
    s_cmp_lg_u32 s4, 0
    s_cbranch_scc1 L_FIN
    ds_read_b64_tr_b16 v[40:41], v198 offset:0
    ds_read_b64_tr_b16 v[42:43], v198 offset:256
    s_waitcnt lgkmcnt(2)
    v_mfma_f32_16x16x32_bf16 v[8:11], v[128:131], v[24:27], 0
    ds_read_b64_tr_b16 v[44:45], v198 offset:512
    ds_read_b64_tr_b16 v[46:47], v198 offset:768
    v_mfma_f32_16x16x32_bf16 v[12:15], v[128:131], v[28:31], 0
    ds_read_b64_tr_b16 v[48:49], v200 offset:0
    ds_read_b64_tr_b16 v[50:51], v200 offset:256
    v_mfma_f32_16x16x32_bf16 v[16:19], v[128:131], v[32:35], 0
    ds_read_b64_tr_b16 v[52:53], v200 offset:512
    ds_read_b64_tr_b16 v[54:55], v200 offset:768
    v_mfma_f32_16x16x32_bf16 v[20:23], v[128:131], v[36:39], 0
    ds_read_b64_tr_b16 v[56:57], v202 offset:0
    ds_read_b64_tr_b16 v[58:59], v202 offset:256
    s_waitcnt lgkmcnt(5)
    v_mfma_f32_16x16x32_bf16 v[8:11], v[132:135], v[40:43], v[8:11]
    ds_read_b64_tr_b16 v[60:61], v202 offset:512
    ds_read_b64_tr_b16 v[62:63], v202 offset:768
    v_mfma_f32_16x16x32_bf16 v[12:15], v[132:135], v[44:47], v[12:15]
    ds_read_b64_tr_b16 v[64:65], v199 offset:0
    ds_read_b64_tr_b16 v[66:67], v199 offset:256
    s_waitcnt lgkmcnt(5)
    v_mfma_f32_16x16x32_bf16 v[8:11], v[136:139], v[48:51], v[8:11]
    ds_read_b64_tr_b16 v[68:69], v199 offset:512
    ds_read_b64_tr_b16 v[70:71], v199 offset:768
    v_mfma_f32_16x16x32_bf16 v[12:15], v[136:139], v[52:55], v[12:15]
    ds_read_b64_tr_b16 v[72:73], v201 offset:0
    ds_read_b64_tr_b16 v[74:75], v201 offset:256
    s_waitcnt lgkmcnt(5)
    v_mfma_f32_16x16x32_bf16 v[8:11], v[140:143], v[56:59], v[8:11]
    ds_read_b64_tr_b16 v[76:77], v201 offset:512
    ds_read_b64_tr_b16 v[78:79], v201 offset:768
    v_mfma_f32_16x16x32_bf16 v[12:15], v[140:143], v[60:63], v[12:15]
    ds_read_b64_tr_b16 v[80:81], v203 offset:0
    ds_read_b64_tr_b16 v[82:83], v203 offset:256
    s_waitcnt lgkmcnt(5)
    v_mfma_f32_16x16x32_bf16 v[16:19], v[132:135], v[64:67], v[16:19]
    ds_read_b64_tr_b16 v[84:85], v203 offset:512
    ds_read_b64_tr_b16 v[86:87], v203 offset:768
    v_mfma_f32_16x16x32_bf16 v[20:23], v[132:135], v[68:71], v[20:23]
    v_cvt_pk_bf16_f32 v88, v8, v9
    s_waitcnt lgkmcnt(3)
    v_mfma_f32_16x16x32_bf16 v[16:19], v[136:139], v[72:75], v[16:19]
    v_cvt_pk_bf16_f32 v89, v12, v13
    v_mfma_f32_16x16x32_bf16 v[20:23], v[136:139], v[76:79], v[20:23]
    s_nop 1
    v_mfma_f32_16x16x16_bf16 v[96:99], v[88:89], v[144:145], 0
    v_mfma_f32_16x16x16_bf16 v[100:103], v[88:89], v[146:147], 0
    s_nop 1
    s_waitcnt lgkmcnt(0)
    v_mfma_f32_16x16x32_bf16 v[16:19], v[140:143], v[80:83], v[16:19]
    s_nop 1
    v_mfma_f32_16x16x32_bf16 v[20:23], v[140:143], v[84:87], v[20:23]
    s_nop 1
    v_fmac_f32 v96, v148, v100
    v_fmac_f32 v97, v149, v101
    v_fmac_f32 v98, v150, v102
    v_cvt_pk_bf16_f32 v92, v16, v17
    v_fmac_f32 v99, v151, v103
    v_fmac_f32 v100, v152, v96
    v_cvt_pk_bf16_f32 v93, v20, v21
    v_fmac_f32 v101, v153, v97
    v_fmac_f32 v102, v154, v98
    v_mfma_f32_16x16x16_bf16 v[112:115], v[92:93], v[144:145], 0
    v_fmac_f32 v103, v155, v99
    v_fmac_f32 v96, v148, v100
    v_mfma_f32_16x16x16_bf16 v[116:119], v[92:93], v[146:147], 0
    v_fmac_f32 v97, v149, v101
    v_fmac_f32 v98, v150, v102
    v_fmac_f32 v99, v151, v103
    v_cvt_pk_bf16_f32 v8, v96, v97
    v_cvt_pk_bf16_f32 v9, v98, v99
    v_cvt_pk_bf16_f32 v10, v100, v101
    v_cvt_pk_bf16_f32 v11, v102, v103
    s_nop 0
    v_fmac_f32 v112, v156, v116
    v_mfma_f32_16x16x32_bf16 v[64:67], v[8:11], v[164:167], 0
    v_fmac_f32 v113, v157, v117
    v_fmac_f32 v114, v158, v118
    v_mfma_f32_16x16x32_bf16 v[68:71], v[8:11], v[172:175], 0
    v_fmac_f32 v115, v159, v119
    v_fmac_f32 v116, v160, v112
    v_fmac_f32 v117, v161, v113
    v_fmac_f32 v118, v162, v114
    v_fmac_f32 v119, v163, v115
    v_fmac_f32 v112, v156, v116
    v_fmac_f32 v113, v157, v117
    v_fmac_f32 v114, v158, v118
    v_fmac_f32 v115, v159, v119
    v_cvt_pk_bf16_f32 v56, v112, v113
    v_cvt_pk_bf16_f32 v57, v114, v115
    v_cvt_pk_bf16_f32 v58, v116, v117
    v_cvt_pk_bf16_f32 v59, v118, v119
    s_nop 1
    v_mfma_f32_16x16x32_bf16 v[64:67], v[56:59], v[168:171], v[64:67]
    s_nop 1
    v_mfma_f32_16x16x32_bf16 v[68:71], v[56:59], v[176:179], v[68:71]
    s_nop 4
    v_cvt_pk_bf16_f32 v80, v64, v65
    v_cvt_pk_bf16_f32 v81, v66, v67
    s_nop 0
    v_cvt_pk_bf16_f32 v82, v68, v69
    v_cvt_pk_bf16_f32 v83, v70, v71
    s_nop 0
    v_permlane16_swap_b32 v80, v82
    v_permlane16_swap_b32 v81, v83
    buffer_store_dwordx4 v[80:83], v182, s[44:47], s48 offen sc1
    s_lshl_b32 s20, s5, 7
    s_add_u32 s20, s20, 2359296
    v_mov_b32 v4, s20
    v_mov_b32 v6, s34
    v_mov_b32 v7, s35
    s_mov_b64 exec, 1
    global_store_dwordx2 v4, v[6:7], s[12:13]
    s_mov_b64 exec, -1
L_FIN:
L_END:
    s_endpgm
.p2align 8
.type K2_TAB,@object
K2_TAB:
.quad 0x8000000080000000,0x8000000080000000,0xbdbb3823bdc9b5dc,0xbd9e4a93bdacbf2a,0xbe3ccc0abe4bafaf,0xbe1f3e1bbe2dfc0f,0xbe8f9fc1be9b5042,0xbe7149d6be84125f
.quad 0xbec370cfbed413cd,0xbea33067beb32814,0xbefb011bbf08d5b9,0xbecfe210bee51af3,0xbf1be416bf2b0dc1,0xbeff791abf0d7c78,0xbf3ddccfbf521801,0xbf1970c4bf2b0dc1
.quad 0xbf64c68dbf800000,0xbf35a446bf4c2737,0xbf894e5cbf9bf7ec,0xbf551d91bf7206d7,0xbfa53539bfbf90c7,0xbf78eb07bf8f3b69,0xbfc89320bfef789e,0xbf914506bfaa150c
.quad 0xbff7c49fc01a827a,0xbfaa150cbfcbb5f9,0xc01da089c052facf,0xbfc89320bff7c49f,0xc052facfc0a0dff7,0xbfef789ec01a827a,0xc09b2dfdc1227363,0xc011c250c048cc39
.quad 0x8000000080000000,0x8000000080000000,0xbd816d0dbd8fd9fe,0xbd49393cbd6606c4,0xbe01f1e9be109095,0xbdc9b5dcbde6c112,0xbe443b4dbe5aa8a8,0xbe17e564be2dfc0f
.quad 0xbe84125fbe938131,0xbe4bafafbe69b8a8,0xbea72734bebb41c0,0xbe803fd4be938131,0xbecbb66cbee51af3,0xbe9b5042beb32814,0xbef22870bf08d5b9,0xbeb73250bed413cd
.quad 0xbf0d7c78bf20db00,0xbed413cdbef690f3,0xbf235edcbf3b1821,0xbef22870bf0d7c78,0xbf3b1821bf582c37,0xbf08d5b9bf20db00,0xbf551d91bf78eb07,0xbf1970c4bf35a446
.quad 0xbf7206d7bf8f3b69,0xbf2b0dc1bf4c2737,0xbf894e5cbfa53539,0xbf3ddccfbf64c68d,0xbf9bf7ecbfbf90c7,0xbf521801bf800000,0xbfb1beabbfe01d9c,0xbf68065ebf8f3b69
.quad 0x8000000080000000,0x8000000080000000,0xbd0facafbd2c70c9,0xbcac5d3ebce5d869,0xbd8fd9febdacbf2a,0xbd2c70c9bd6606c4,0xbdd838b7be01f1e9,0xbd816d0dbdacbf2a
.quad 0xbe109095be2dfc0f,0xbdacbf2abde6c112,0xbe3561b1be5aa8a8,0xbdd838b7be109095,0xbe5aa8a8be84125f,0xbe01f1e9be2dfc0f,0xbe803fd4be9b5042,0xbe17e564be4bafaf
.quad 0xbe938131beb32814,0xbe2dfc0fbe69b8a8,0xbea72734becbb66c,0xbe443b4dbe84125f,0xbebb41c0bee51af3,0xbe5aa8a8be938131,0xbecfe210beff791a,0xbe7149d6bea33067
.quad 0xbee51af3bf0d7c78,0xbe84125fbeb32814,0xbefb011bbf1be416,0xbe8f9fc1bec370cf,0xbf08d5b9bf2b0dc1,0xbe9b5042bed413cd,0xbf1499c2bf3b1821,0xbea72734bee51af3
.quad 0x8000000080000000,0,0xbbe5c9f1bc65ccd5,0x3be5c9f100000000,0xbc65ccd5bce5d869,0x3c65ccd500000000,0xbcac5d3ebd2c70c9,0x3cac5d3e00000000
.quad 0xbce5d869bd6606c4,0x3ce5d86900000000,0xbd0facafbd8fd9fe,0x3d0facaf00000000,0xbd2c70c9bdacbf2a,0x3d2c70c900000000,0xbd49393cbdc9b5dc,0x3d49393c00000000
.quad 0xbd6606c4bde6c112,0x3d6606c400000000,0xbd816d0dbe01f1e9,0x3d816d0d00000000,0xbd8fd9febe109095,0x3d8fd9fe00000000,0xbd9e4a93be1f3e1b,0x3d9e4a9300000000
.quad 0xbdacbf2abe2dfc0f,0x3dacbf2a00000000,0xbdbb3823be3ccc0a,0x3dbb382300000000,0xbdc9b5dcbe4bafaf,0x3dc9b5dc00000000,0xbdd838b7be5aa8a8,0x3dd838b700000000
.quad 0,0,0x3e39aaee3e47c5c2,0x3e1d59f03e2b86c0,0x3eb697193ec3ef15,0x3e9b7b853ea91a56,0x3f0525983f0e39da,0x3ee498983ef7aa01
.quad 0x3f2a95b03f3504f3,0x3f1423cd3f1f9d07,0x3f4a5e203f54db31,0x3f32767c3f3ee268,0x3f63712c3f6c835e,0x3f4c8bf33f58c2eb,0x3f74fa0b3f7b14be,0x3f61c5983f6c835e
.quad 0x3f7e63ec3f800000,0x3f71a2573f7994e0,0x3f7f5eee3f7b14be,0x3f7bc1bb3f7f98e6,0x3f77e2bd3f6c835e,0x3f7fe6383f7e63ec,0x3f682ee03f54db31,0x3f7df69c3f75fead
.quad 0x3f50c8993f3504f3,0x3f75fead3f66a5e5,0x3f32767c3f0e39da,0x3f682ee03f50c899,0x3f0e39da3ec3ef15,0x3f54db313f3504f3,0x3eca8c723e47c5c2,0x3f3c79273f1423cd
.quad 0,0,0x3e00e9413e0f2533,0x3dc8bd363de54da2,0x3e7fc5683e8dbd62,0x3e47c5c23e63dc87,0x3ebd47db3ed11f9b,0x3e94a0313ea91a56
.quad 0x3ef7aa013f083341,0x3ec3ef153ede2602,0x3f170daa3f2529fe,0x3ef15aea3f083341,0x3f2fdf083f3ee268,0x3f0e39da3f1f9d07,0x3f45e4033f54db31,0x3f2267993f3504f3
.quad 0x3f58c2eb3f66a5e5,0x3f3504f33f48261c,0x3f682ee03f73e912,0x3f45e4033f58c2eb,0x3f73e9123f7c620b,0x3f54db313f66a5e5,0x3f7bc1bb3f7fe638,0x3f61c5983f71a257
.quad 0x3f7f98e63f7e63ec,0x3f6c835e3f7994e0,0x3f7f5eee3f77e2bd,0x3f74fa0b3f7e63ec,0x3f7b14be3f6c835e,0x3f7b14be3f800000,0x3f72cbd13f5c7efc,0x3f7ec46d3f7e63ec
.quad 0,0,0x3d8f7f7c3dac22ae,0x3d2c49b73d65aa20,0x3e0f25333e2b86c0,0x3dac22ae3de54da2,0x3e55d6873e7fc568,0x3e00e9413e2b86c0
.quad 0x3e8dbd623ea91a56,0x3e2b86c03e63dc87,0x3eafdd253ed11f9b,0x3e55d6873e8dbd62,0x3ed11f9b3ef7aa01,0x3e7fc5683ea91a56,0x3ef15aea3f0e39da,0x3e94a0313ec3ef15
.quad 0x3f0833413f1f9d07,0x3ea91a563ede2602,0x3f170daa3f2fdf08,0x3ebd47db3ef7aa01,0x3f2529fe3f3ee268,0x3ed11f9b3f083341,0x3f32767c3f4c8bf3,0x3ee498983f1423cd
.quad 0x3f3ee2683f58c2eb,0x3ef7aa013f1f9d07,0x3f4a5e203f63712c,0x3f0525983f2a95b0,0x3f54db313f6c835e,0x3f0e39da3f3504f3,0x3f5e4c693f73e912,0x3f170daa3f3ee268
.quad 0,0x8000000080000000,0x3c65c70c3ce5c143,0xbc65c70c80000000,0x3ce5c1433d65aa20,0xbce5c14380000000,0x3d2c49b73dac22ae,0xbd2c49b780000000
.quad 0x3d65aa203de54da2,0xbd65aa2080000000,0x3d8f7f7c3e0f2533,0xbd8f7f7c80000000,0x3dac22ae3e2b86c0,0xbdac22ae80000000,0x3dc8bd363e47c5c2,0xbdc8bd3680000000
.quad 0x3de54da23e63dc87,0xbde54da280000000,0x3e00e9413e7fc568,0xbe00e94180000000,0x3e0f25333e8dbd62,0xbe0f253380000000,0x3e1d59f03e9b7b85,0xbe1d59f080000000
.quad 0x3e2b86c03ea91a56,0xbe2b86c080000000,0x3e39aaee3eb69719,0xbe39aaee80000000,0x3e47c5c23ec3ef15,0xbe47c5c280000000,0x3e55d6873ed11f9b,0xbe55d68780000000
.quad 0,0,0x3cac5d3e3c65ccd5,0x3d0facaf3ce5d869,0x3d2c70c93ce5d869,0x3d8fd9fe3d6606c4,0x3d816d0d3d2c70c9,0x3dd838b73dacbf2a
.quad 0x3dacbf2a3d6606c4,0x3e1090953de6c112,0x3dd838b73d8fd9fe,0x3e3561b13e109095,0x3e01f1e93dacbf2a,0x3e5aa8a83e2dfc0f,0x3e17e5643dc9b5dc,0x3e803fd43e4bafaf
.quad 0x3e2dfc0f3de6c112,0x3e9381313e69b8a8,0x3e443b4d3e01f1e9,0x3ea727343e84125f,0x3e5aa8a83e109095,0x3ebb41c03e938131,0x3e7149d63e1f3e1b,0x3ecfe2103ea33067
.quad 0x3e84125f3e2dfc0f,0x3ee51af33eb32814,0x3e8f9fc13e3ccc0a,0x3efb011b3ec370cf,0x3e9b50423e4bafaf,0x3f08d5b93ed413cd,0x3ea727343e5aa8a8,0x3f1499c23ee51af3
.quad 0,0,0x3d49393c3d2c70c9,0x3d816d0d3d6606c4,0x3dc9b5dc3dacbf2a,0x3e01f1e93de6c112,0x3e17e5643e01f1e9,0x3e443b4d3e2dfc0f
.quad 0x3e4bafaf3e2dfc0f,0x3e84125f3e69b8a8,0x3e803fd43e5aa8a8,0x3ea727343e938131,0x3e9b50423e84125f,0x3ecbb66c3eb32814,0x3eb732503e9b5042,0x3ef228703ed413cd
.quad 0x3ed413cd3eb32814,0x3f0d7c783ef690f3,0x3ef228703ecbb66c,0x3f235edc3f0d7c78,0x3f08d5b93ee51af3,0x3f3b18213f20db00,0x3f1970c43eff791a,0x3f551d913f35a446
.quad 0x3f2b0dc13f0d7c78,0x3f7206d73f4c2737,0x3f3ddccf3f1be416,0x3f894e5c3f64c68d,0x3f5218013f2b0dc1,0x3f9bf7ec3f800000,0x3f68065e3f3b1821,0x3fb1beab3f8f3b69
.quad 0,0,0x3d9e4a933d8fd9fe,0x3dbb38233dacbf2a,0x3e1f3e1b3e109095,0x3e3ccc0a3e2dfc0f,0x3e7149d63e5aa8a8,0x3e8f9fc13e84125f
.quad 0x3ea330673e938131,0x3ec370cf3eb32814,0x3ecfe2103ebb41c0,0x3efb011b3ee51af3,0x3eff791a3ee51af3,0x3f1be4163f0d7c78,0x3f1970c43f08d5b9,0x3f3ddccf3f2b0dc1
.quad 0x3f35a4463f20db00,0x3f64c68d3f4c2737,0x3f551d913f3b1821,0x3f894e5c3f7206d7,0x3f78eb073f582c37,0x3fa535393f8f3b69,0x3f9145063f78eb07,0x3fc893203faa150c
.quad 0x3faa150c3f8f3b69,0x3ff7c49f3fcbb5f9,0x3fc893203fa53539,0x401da0893ff7c49f,0x3fef789e3fbf90c7,0x4052facf401a827a,0x4011c2503fe01d9c,0x409b2dfd4048cc39
.quad 0,0,0x3dc9b5dc,0,0x3e4bafaf,0,0x3e9b5042,0
.quad 0x3ed413cd,0,0x3f08d5b9,0,0x3f2b0dc1,0,0x3f521801,0
.quad 0x3f800000,0,0x3f9bf7ec,0,0x3fbf90c7,0,0x3fef789e,0
.quad 0x401a827a,0,0x4052facf,0,0x40a0dff7,0,0x41227363,0
.quad 0x8000000080000000,0x8000000080000000,0xbd2c49b7bce5c143,0xbd8f7f7cbd65aa20,0xbdac22aebd65aa20,0xbe0f2533bde54da2,0xbe00e941bdac22ae,0xbe55d687be2b86c0
.quad 0xbe2b86c0bde54da2,0xbe8dbd62be63dc87,0xbe55d687be0f2533,0xbeafdd25be8dbd62,0xbe7fc568be2b86c0,0xbed11f9bbea91a56,0xbe94a031be47c5c2,0xbef15aeabec3ef15
.quad 0xbea91a56be63dc87,0xbf083341bede2602,0xbebd47dbbe7fc568,0xbf170daabef7aa01,0xbed11f9bbe8dbd62,0xbf2529febf083341,0xbee49898be9b7b85,0xbf32767cbf1423cd
.quad 0xbef7aa01bea91a56,0xbf3ee268bf1f9d07,0xbf052598beb69719,0xbf4a5e20bf2a95b0,0xbf0e39dabec3ef15,0xbf54db31bf3504f3,0xbf170daabed11f9b,0xbf5e4c69bf3ee268
.quad 0x8000000080000000,0x8000000080000000,0xbdc8bd36bdac22ae,0xbe00e941bde54da2,0xbe47c5c2be2b86c0,0xbe7fc568be63dc87,0xbe94a031be7fc568,0xbebd47dbbea91a56
.quad 0xbec3ef15bea91a56,0xbef7aa01bede2602,0xbef15aeabed11f9b,0xbf170daabf083341,0xbf0e39dabef7aa01,0xbf2fdf08bf1f9d07,0xbf226799bf0e39da,0xbf45e403bf3504f3
.quad 0xbf3504f3bf1f9d07,0xbf58c2ebbf48261c,0xbf45e403bf2fdf08,0xbf682ee0bf58c2eb,0xbf54db31bf3ee268,0xbf73e912bf66a5e5,0xbf61c598bf4c8bf3,0xbf7bc1bbbf71a257
.quad 0xbf6c835ebf58c2eb,0xbf7f98e6bf7994e0,0xbf74fa0bbf63712c,0xbf7f5eeebf7e63ec,0xbf7b14bebf6c835e,0xbf7b14bebf800000,0xbf7ec46dbf73e912,0xbf72cbd1bf7e63ec
.quad 0x8000000080000000,0x8000000080000000,0xbe1d59f0be0f2533,0xbe39aaeebe2b86c0,0xbe9b7b85be8dbd62,0xbeb69719bea91a56,0xbee49898bed11f9b,0xbf052598bef7aa01
.quad 0xbf1423cdbf083341,0xbf2a95b0bf1f9d07,0xbf32767cbf2529fe,0xbf4a5e20bf3ee268,0xbf4c8bf3bf3ee268,0xbf63712cbf58c2eb,0xbf61c598bf54db31,0xbf74fa0bbf6c835e
.quad 0xbf71a257bf66a5e5,0xbf7e63ecbf7994e0,0xbf7bc1bbbf73e912,0xbf7f5eeebf7f98e6,0xbf7fe638bf7c620b,0xbf77e2bdbf7e63ec,0xbf7df69cbf7fe638,0xbf682ee0bf75fead
.quad 0xbf75feadbf7e63ec,0xbf50c899bf66a5e5,0xbf682ee0bf77e2bd,0xbf32767cbf50c899,0xbf54db31bf6c835e,0xbf0e39dabf3504f3,0xbf3c7927bf5c7efc,0xbeca8c72bf1423cd
.quad 0x80000000,0,0xbe47c5c2,0,0xbec3ef15,0,0xbf0e39da,0
.quad 0xbf3504f3,0,0xbf54db31,0,0xbf6c835e,0,0xbf7b14be,0
.quad 0xbf800000,0,0xbf7b14be,0,0xbf6c835e,0,0xbf54db31,0
.quad 0xbf3504f3,0,0xbf0e39da,0,0xbec3ef15,0,0xbe47c5c2,0
.quad 0x3f803f803f803f80,0,0x3f483f673f7a3f80,0x3f203ede3e640000,0x3e643f203f673f80,0x3f7a3f483ede0000,0xbede3e643f483f80,0x3f673f7a3f200000
.quad 0xbf67be643f203f80,0x3ede3f7a3f480000,0xbf7abf203ede3f80,0xbe643f483f670000,0xbf20bf673e643f80,0xbf483ede3f7a0000,0xbf8000003f80,0xbf8000003f800000
.quad 0x3f20bf67be643f80,0xbf48bede3f7a0000,0x3f7abf20bede3f80,0xbe64bf483f670000,0x3f67be64bf203f80,0x3edebf7a3f480000,0x3ede3e64bf483f80,0x3f67bf7a3f200000
.quad 0xbe643f20bf673f80,0x3f7abf483ede0000,0xbf483f67bf7a3f80,0x3f20bede3e640000,0xbf803f80bf803f80,0,0xbf483f67bf7a3f80,0xbf203edebe640000
.quad 0x3f803f803f803f80,0,0x3e643ede3f20,0x3f803f7a3f673f48,0xbf80bf67bf20be64,0x3ede3f483f7a,0xbf20bf7abf67,0xbf80bf48be643ede
.quad 0x3f803f20be64bf67,0xbf48bf7abede,0x3f673f48be64,0x3f803edebf20bf7a,0xbf80be643f673f20,0x3f7a3edebf48,0xbf8000003f80,0xbf8000003f800000
.quad 0x3f80be64bf673f20,0xbf7a3ede3f48,0x3f67bf48be64,0x3f80bedebf203f7a,0xbf803f203e64bf67,0x3f48bf7a3ede,0xbf203f7abf67,0xbf803f48be64bede
.quad 0x3f80bf673f20be64,0xbede3f48bf7a,0x3e64bede3f20,0x3f80bf7a3f67bf48,0xbf803f80bf803f80,0,0x3e64bede3f20,0xbf803f7abf673f48
.quad 0x3f803f803f803f80,0,0xbf48bf20bedebe64,0x3f203f483f673f7a,0x3e64be64bf20bf67,0xbf7abf7abf48bede,0x3ede3f673f7a3f20,0x3f673edebe64bf48
.quad 0xbf67bf67be643f20,0xbede3ede3f7a3f48,0x3f7a3e64bf48bf67,0xbe64bf7abf203ede,0xbf203f203f67be64,0x3f483f48bedebf7a,0xbf8000003f80,0xbf8000003f800000
.quad 0x3f203f20bf67be64,0x3f48bf48bede3f7a,0xbf7a3e643f48bf67,0xbe643f7abf20bede,0x3f67bf673e643f20,0xbedebede3f7abf48,0xbede3f67bf7a3f20,0x3f67bedebe643f48
.quad 0xbe64be643f20bf67,0xbf7a3f7abf483ede,0x3f48bf203edebe64,0x3f20bf483f67bf7a,0xbf803f80bf803f80,0,0x3f48bf203edebe64,0xbf203f48bf673f7a
.quad 0x3f803f803f803f80,0,0xbf7abf80bf7abf67,0xbe6400003e643ede,0x3f673f803f673f20,0x3ede0000bedebf48,0xbf48bf80bf48be64,0xbf2000003f203f7a
.quad 0x3f203f803f20be64,0x3f480000bf48bf7a,0xbedebf80bede3f20,0xbf6700003f673f48,0x3e643f803e64bf67,0x3f7a0000bf7abede,0xbf8000003f80,0xbf8000003f800000
.quad 0xbe643f80be64bf67,0x3f7a0000bf7a3ede,0x3edebf803ede3f20,0xbf6700003f67bf48,0xbf203f80bf20be64,0x3f480000bf483f7a,0x3f48bf803f48be64,0xbf2000003f20bf7a
.quad 0xbf673f80bf673f20,0x3ede0000bede3f48,0x3f7abf803f7abf67,0xbe6400003e64bede,0xbf803f80bf803f80,0,0x3f7abf803f7abf67,0x3e640000be643ede
.quad 0x3f803f803f803f80,0,0xbedebf20bf48bf67,0xbf67bf48bf20bede,0xbf20be643e643f20,0x3f483f7a3f7a3f48,0x3f7a3f673edebe64,0x3e64bedebf67bf7a
.quad 0xbe64bf67bf67be64,0xbf7abede3ede3f7a,0xbf483e643f7a3f20,0x3f203f7a3e64bf48,0x3f673f20bf20bf67,0x3edebf48bf483ede,0xbf8000003f80,0xbf8000003f800000
.quad 0xbf673f203f20bf67,0x3ede3f48bf48bede,0x3f483e64bf7a3f20,0x3f20bf7a3e643f48,0x3e64bf673f67be64,0xbf7a3ede3edebf7a,0xbf7a3f67bedebe64,0x3e643edebf673f7a
.quad 0x3f20be64be643f20,0x3f48bf7a3f7abf48,0x3edebf203f48bf67,0xbf673f48bf203ede,0xbf803f80bf803f80,0,0x3edebf203f48bf67,0x3f67bf483f20bede
.quad 0x3f803f803f803f80,0,0x3ede3e640000be64,0xbf67bf7abf80bf7a,0xbf20bf67bf80bf67,0xbf48bede00003ede,0xbf7abf2000003f20,0x3e643f483f803f48
.quad 0xbe643f203f803f20,0x3f7a3f480000bf48,0x3f483f670000bf67,0x3f20bedebf80bede,0x3f67be64bf80be64,0xbedebf7a00003f7a,0xbf8000003f80,0xbf8000003f800000
.quad 0xbf67be643f80be64,0xbede3f7a0000bf7a,0xbf483f670000bf67,0x3f203edebf803ede,0x3e643f20bf803f20,0x3f7abf4800003f48,0x3f7abf2000003f20,0x3e64bf483f80bf48
.quad 0x3f20bf673f80bf67,0xbf483ede0000bede,0xbede3e640000be64,0xbf673f7abf803f7a,0xbf803f80bf803f80,0,0xbede3e640000be64,0x3f67bf7a3f80bf7a
.quad 0x3f803f803f803f80,0,0x3f7a3f673f483f20,0xbe64bedebf20bf48,0x3f673f203e64be64,0xbedebf48bf7abf7a,0x3f483e64bedebf67,0xbf20bf7abf67bede
.quad 0x3f20be64bf67bf67,0xbf48bf7abede3ede,0x3edebf20bf7abe64,0xbf67bf483e643f7a,0x3e64bf67bf203f20,0xbf7abede3f483f48,0xbf8000003f80,0xbf8000003f800000
.quad 0xbe64bf673f203f20,0xbf7a3ede3f48bf48,0xbedebf203f7abe64,0xbf673f483e64bf7a,0xbf20be643f67bf67,0xbf483f7abedebede,0xbf483e643edebf67,0xbf203f7abf673ede
.quad 0xbf673f20be64be64,0xbede3f48bf7a3f7a,0xbf7a3f67bf483f20,0xbe643edebf203f48,0xbf803f80bf803f80,0,0xbf7a3f67bf483f20,0x3e64bede3f20bf48
.quad 0x3f80,0,0x3f80,0,0x3f80,0,0x3f80,0
.quad 0x3f80,0,0x3f80,0,0x3f80,0,0x3f80,0
.quad 0x3f80,0,0x3f80,0,0x3f80,0,0x3f80,0
.quad 0x3f80,0,0x3f80,0,0x3f80,0,0x3f80,0
.quad 0xbe643f20bf673f80,0xbf7a3f48bede0000,0x3ede3e64bf483f80,0xbf673f7abf200000,0x3f67be64bf203f80,0xbede3f7abf480000,0x3f7abf20bede3f80,0x3e643f48bf670000
.quad 0x3f20bf67be643f80,0x3f483edebf7a0000,0xbf8000003f80,0x3f800000bf800000,0xbf20bf673e643f80,0x3f48bedebf7a0000,0xbf7abf203ede3f80,0x3e64bf48bf670000
.quad 0xbf67be643f203f80,0xbedebf7abf480000,0xbede3e643f483f80,0xbf67bf7abf200000,0x3e643f203f673f80,0xbf7abf48bede0000,0x3f483f673f7a3f80,0xbf20bedebe640000
.quad 0,0,0,0,0,0,0,0
.quad 0x3f80bf673f20be64,0x3edebf483f7a,0xbf203f7abf67,0x3f80bf483e643ede,0xbf803f203e64bf67,0xbf483f7abede,0x3f67bf48be64,0xbf803ede3f20bf7a
.quad 0x3f80be64bf673f20,0x3f7abedebf48,0xbf8000003f80,0x3f800000bf800000,0xbf80be643f673f20,0xbf7abede3f48,0x3f673f48be64,0xbf80bede3f203f7a
.quad 0x3f803f20be64bf67,0x3f483f7a3ede,0xbf20bf7abf67,0x3f803f483e64bede,0xbf80bf67bf20be64,0xbedebf48bf7a,0x3e643ede3f20,0xbf80bf7abf67bf48
.quad 0,0,0,0,0,0,0,0
.quad 0xbe64be643f20bf67,0x3f7abf7a3f48bede,0xbede3f67bf7a3f20,0xbf673ede3e64bf48,0x3f67bf673e643f20,0x3ede3edebf7a3f48,0xbf7a3e643f48bf67,0x3e64bf7a3f203ede
.quad 0x3f203f20bf67be64,0xbf483f483edebf7a,0xbf8000003f80,0x3f800000bf800000,0xbf203f203f67be64,0xbf48bf483ede3f7a,0x3f7a3e64bf48bf67,0x3e643f7a3f20bede
.quad 0xbf67bf67be643f20,0x3edebedebf7abf48,0x3ede3f673f7a3f20,0xbf67bede3e643f48,0x3e64be64bf20bf67,0x3f7a3f7a3f483ede,0xbf48bf20bedebe64,0xbf20bf48bf67bf7a
.quad 0,0,0,0,0,0,0,0
.quad 0xbf673f80bf673f20,0xbede00003edebf48,0x3f48bf803f48be64,0x3f200000bf203f7a,0xbf203f80bf20be64,0xbf4800003f48bf7a,0x3edebf803ede3f20,0x3f670000bf673f48
.quad 0xbe643f80be64bf67,0xbf7a00003f7abede,0xbf8000003f80,0x3f800000bf800000,0x3e643f803e64bf67,0xbf7a00003f7a3ede,0xbedebf80bede3f20,0x3f670000bf67bf48
.quad 0x3f203f803f20be64,0xbf4800003f483f7a,0xbf48bf80bf48be64,0x3f200000bf20bf7a,0x3f673f803f673f20,0xbede00003ede3f48,0xbf7abf80bf7abf67,0x3e640000be64bede
.quad 0,0,0,0,0,0,0,0
.quad 0x3f20be64be643f20,0xbf483f7abf7a3f48,0xbf7a3f67bedebe64,0xbe64bede3f67bf7a,0x3e64bf673f67be64,0x3f7abedebede3f7a,0x3f483e64bf7a3f20,0xbf203f7abe64bf48
.quad 0xbf673f203f20bf67,0xbedebf483f483ede,0xbf8000003f80,0x3f800000bf800000,0x3f673f20bf20bf67,0xbede3f483f48bede,0xbf483e643f7a3f20,0xbf20bf7abe643f48
.quad 0xbe64bf67bf67be64,0x3f7a3edebedebf7a,0x3f7a3f673edebe64,0xbe643ede3f673f7a,0xbf20be643e643f20,0xbf48bf7abf7abf48,0xbedebf20bf48bf67,0x3f673f483f203ede
.quad 0,0,0,0,0,0,0,0
.quad 0x3f20bf673f80bf67,0x3f48bede00003ede,0x3f7abf2000003f20,0xbe643f48bf803f48,0x3e643f20bf803f20,0xbf7a3f480000bf48,0xbf483f670000bf67,0xbf20bede3f80bede
.quad 0xbf67be643f80be64,0x3edebf7a00003f7a,0xbf8000003f80,0x3f800000bf800000,0x3f67be64bf80be64,0x3ede3f7a0000bf7a,0x3f483f670000bf67,0xbf203ede3f803ede
.quad 0xbe643f203f803f20,0xbf7abf4800003f48,0xbf7abf2000003f20,0xbe64bf48bf80bf48,0xbf20bf67bf80bf67,0x3f483ede0000bede,0x3ede3e640000be64,0x3f673f7a3f803f7a
.quad 0,0,0,0,0,0,0,0
.quad 0xbf673f20be64be64,0x3edebf483f7abf7a,0xbf483e643edebf67,0x3f20bf7a3f67bede,0xbf20be643f67bf67,0x3f48bf7a3ede3ede,0xbedebf203f7abe64,0x3f67bf48be643f7a
.quad 0xbe64bf673f203f20,0x3f7abedebf483f48,0xbf8000003f80,0x3f800000bf800000,0x3e64bf67bf203f20,0x3f7a3edebf48bf48,0x3edebf20bf7abe64,0x3f673f48be64bf7a
.quad 0x3f20be64bf67bf67,0x3f483f7a3edebede,0x3f483e64bedebf67,0x3f203f7a3f673ede,0x3f673f203e64be64,0x3ede3f483f7a3f7a,0x3f7a3f673f483f20,0x3e643ede3f203f48
.quad 0,0,0,0,0,0,0,0
.quad 0x3f80,0,0x3f80,0,0x3f80,0,0x3f80,0
.quad 0x3f80,0,0x3f80,0,0x3f80,0,0x3f80,0
.quad 0x3f80,0,0x3f80,0,0x3f80,0,0x3f80,0
.quad 0,0,0,0,0,0,0,0
.quad 0x3f8000003f80,0x3f8080003f808000,0x3f0e3f553e483f7b,0x3f55bf0e3f7bbe48,0x3f6d3ec43ec43f6d,0x3ec4bf6d3f6dbec4,0x3f7bbe483f0e3f55,0xbe48bf7b3f55bf0e
.quad 0x3f35bf353f353f35,0xbf35bf353f35bf35,0x3e48bf7b3f553f0e,0xbf7bbe483f0ebf55,0xbec4bf6d3f6d3ec4,0xbf6d3ec43ec4bf6d,0xbf55bf0e3f7b3e48,0xbf0e3f553e48bf7b
.quad 0xbf8000003f800000,0x3f800000bf80,0xbf553f0e3f7bbe48,0x3f0e3f55be48bf7b,0xbec43f6d3f6dbec4,0x3f6d3ec4bec4bf6d,0x3e483f7b3f55bf0e,0x3f7bbe48bf0ebf55
.quad 0x3f353f353f35bf35,0x3f35bf35bf35bf35,0x3f7b3e483f0ebf55,0x3e48bf7bbf55bf0e,0x3f6dbec43ec4bf6d,0xbec4bf6dbf6dbec4,0x3f0ebf553e48bf7b,0xbf55bf0ebf7bbe48
.quad 0x3f8000003f80,0x3f8080003f808000,0x3f7b3e483f553f0e,0x3e48bf7b3f0ebf55,0x3ec4bf6d3f6dbec4,0xbf6dbec4bec4bf6d,0xbf55bf0e3e48bf7b,0xbf0e3f55bf7bbe48
.quad 0xbf353f35bf35bf35,0x3f353f35bf353f35,0x3f0e3f55bf7b3e48,0x3f55bf0e3e483f7b,0x3f6dbec4bec43f6d,0xbec4bf6d3f6d3ec4,0xbe48bf7b3f0e3f55,0xbf7b3e483f55bf0e
.quad 0xbf8000003f800000,0x3f800000bf80,0xbe483f7b3f0ebf55,0x3f7b3e48bf55bf0e,0x3f6d3ec4bec4bf6d,0x3ec4bf6dbf6d3ec4,0x3f0ebf55bf7bbe48,0xbf55bf0ebe483f7b
.quad 0xbf35bf35bf353f35,0xbf353f353f353f35,0xbf553f0e3e483f7b,0x3f0e3f553f7bbe48,0x3ec43f6d3f6d3ec4,0x3f6dbec43ec4bf6d,0x3f7bbe483f55bf0e,0xbe48bf7bbf0ebf55
.quad 0x3f8000003f80,0x3f8080003f808000,0x3f55bf0e3f7bbe48,0xbf0ebf55be48bf7b,0xbf6dbec4bec4bf6d,0xbec43f6dbf6d3ec4,0x3e483f7bbf553f0e,0x3f7bbe483f0e3f55
.quad 0x3f35bf353f353f35,0xbf35bf353f35bf35,0xbf7bbe483f0ebf55,0xbe483f7bbf55bf0e,0x3ec43f6dbf6dbec4,0x3f6dbec4bec43f6d,0x3f0ebf55be483f7b,0xbf55bf0e3f7b3e48
.quad 0xbf8000003f800000,0x3f800000bf80,0x3f0e3f55be48bf7b,0x3f55bf0ebf7b3e48,0x3ec4bf6dbf6d3ec4,0xbf6dbec43ec43f6d,0xbf7b3e483f0e3f55,0x3e483f7b3f55bf0e
.quad 0x3f353f353f35bf35,0x3f35bf35bf35bf35,0x3e48bf7bbf55bf0e,0xbf7bbe48bf0e3f55,0xbf6d3ec4bec43f6d,0x3ec43f6d3f6d3ec4,0x3f553f0e3f7b3e48,0x3f0ebf553e48bf7b
.quad 0x3f8000003f80,0x3f8080003f808000,0x3e48bf7b3f0ebf55,0xbf7bbe48bf55bf0e,0xbec43f6dbf6d3ec4,0x3f6d3ec43ec43f6d,0x3f0ebf553f7b3e48,0xbf55bf0e3e48bf7b
.quad 0xbf353f35bf35bf35,0x3f353f35bf353f35,0x3f55bf0e3e483f7b,0xbf0ebf553f7bbe48,0xbf6d3ec43ec4bf6d,0x3ec43f6dbf6dbec4,0x3f7bbe48bf553f0e,0xbe48bf7b3f0e3f55
.quad 0xbf8000003f800000,0x3f800000bf80,0x3f7b3e48bf55bf0e,0x3e48bf7bbf0e3f55,0xbf6dbec43ec43f6d,0xbec43f6d3f6dbec4,0x3f553f0e3e48bf7b,0x3f0ebf55bf7bbe48
.quad 0xbf35bf35bf353f35,0xbf353f353f353f35,0x3f0e3f553f7bbe48,0x3f55bf0ebe48bf7b,0xbec4bf6dbf6dbec4,0xbf6d3ec4bec43f6d,0x3e483f7b3f0e3f55,0x3f7bbe483f55bf0e
.quad 0x3f8000003f80,0x3f8000003f80,0x3f8080003f808000,0x3f8080003f808000,0x3ec43f6d00003f80,0x3f6d3ec43f353f35,0x3f6dbec43f808000,0x3ec4bf6d3f35bf35
.quad 0x3f8000003f80,0x3f8000003f80,0x3f8080003f808000,0x3f8080003f808000,0x3ec43f6d00003f80,0x3f6d3ec43f353f35,0x3f6dbec43f808000,0x3ec4bf6d3f35bf35
.quad 0x3f8000003f80,0x3f8000003f80,0x3f8080003f808000,0x3f8080003f808000,0x3ec43f6d00003f80,0x3f6d3ec43f353f35,0x3f6dbec43f808000,0x3ec4bf6d3f35bf35
.quad 0x3f8000003f80,0x3f8000003f80,0x3f8080003f808000,0x3f8080003f808000,0x3ec43f6d00003f80,0x3f6d3ec43f353f35,0x3f6dbec43f808000,0x3ec4bf6d3f35bf35
.quad 0x3f8000003f80,0x3f8000003f80,0x3f8080003f808000,0x3f8080003f808000,0x3f6dbec43f800000,0x3ec4bf6d3f35bf35,0xbec4bf6d0000bf80,0xbf6dbec4bf35bf35
.quad 0x3f8000003f80,0x3f8000003f80,0x3f8080003f808000,0x3f8080003f808000,0x3f6dbec43f800000,0x3ec4bf6d3f35bf35,0xbec4bf6d0000bf80,0xbf6dbec4bf35bf35
.quad 0x3f8000003f80,0x3f8000003f80,0x3f8080003f808000,0x3f8080003f808000,0x3f6dbec43f800000,0x3ec4bf6d3f35bf35,0xbec4bf6d0000bf80,0xbf6dbec4bf35bf35
.quad 0x3f8000003f80,0x3f8000003f80,0x3f8080003f808000,0x3f8080003f808000,0x3f6dbec43f800000,0x3ec4bf6d3f35bf35,0xbec4bf6d0000bf80,0xbf6dbec4bf35bf35
.quad 0x3f8000003f80,0x3f8000003f80,0x3f8080003f808000,0x3f8080003f808000,0xbec4bf6d0000bf80,0xbf6dbec4bf35bf35,0xbf6d3ec4bf808000,0xbec43f6dbf353f35
.quad 0x3f8000003f80,0x3f8000003f80,0x3f8080003f808000,0x3f8080003f808000,0xbec4bf6d0000bf80,0xbf6dbec4bf35bf35,0xbf6d3ec4bf808000,0xbec43f6dbf353f35
.quad 0x3f8000003f80,0x3f8000003f80,0x3f8080003f808000,0x3f8080003f808000,0xbec4bf6d0000bf80,0xbf6dbec4bf35bf35,0xbf6d3ec4bf808000,0xbec43f6dbf353f35
.quad 0x3f8000003f80,0x3f8000003f80,0x3f8080003f808000,0x3f8080003f808000,0xbec4bf6d0000bf80,0xbf6dbec4bf35bf35,0xbf6d3ec4bf808000,0xbec43f6dbf353f35
.quad 0x3f8000003f80,0x3f8000003f80,0x3f8080003f808000,0x3f8080003f808000,0xbf6d3ec4bf800000,0xbec43f6dbf353f35,0x3ec43f6d00003f80,0x3f6d3ec43f353f35
.quad 0x3f8000003f80,0x3f8000003f80,0x3f8080003f808000,0x3f8080003f808000,0xbf6d3ec4bf800000,0xbec43f6dbf353f35,0x3ec43f6d00003f80,0x3f6d3ec43f353f35
.quad 0x3f8000003f80,0x3f8000003f80,0x3f8080003f808000,0x3f8080003f808000,0xbf6d3ec4bf800000,0xbec43f6dbf353f35,0x3ec43f6d00003f80,0x3f6d3ec43f353f35
.quad 0x3f8000003f80,0x3f8000003f80,0x3f8080003f808000,0x3f8080003f808000,0xbf6d3ec4bf800000,0xbec43f6dbf353f35,0x3ec43f6d00003f80,0x3f6d3ec43f353f35
.quad 0xbf35bf350000bf80,0xbf353f35bf800000,0xbf353f35bf808000,0x3f353f3500003f80,0xbec43f6dbf800000,0x3f6dbec43f353f35,0x3f6d3ec400003f80,0xbec4bf6d3f35bf35
.quad 0xbf35bf350000bf80,0xbf353f35bf800000,0xbf353f35bf808000,0x3f353f3500003f80,0xbec43f6dbf800000,0x3f6dbec43f353f35,0x3f6d3ec400003f80,0xbec4bf6d3f35bf35
.quad 0xbf35bf350000bf80,0xbf353f35bf800000,0xbf353f35bf808000,0x3f353f3500003f80,0xbec43f6dbf800000,0x3f6dbec43f353f35,0x3f6d3ec400003f80,0xbec4bf6d3f35bf35
.quad 0xbf35bf350000bf80,0xbf353f35bf800000,0xbf353f35bf808000,0x3f353f3500003f80,0xbec43f6dbf800000,0x3f6dbec43f353f35,0x3f6d3ec400003f80,0xbec4bf6d3f35bf35
.quad 0x3f353f3500003f80,0x3f35bf353f800000,0x3f35bf353f808000,0xbf35bf350000bf80,0xbf6dbec40000bf80,0x3ec43f6dbf353f35,0xbec43f6dbf808000,0x3f6dbec43f353f35
.quad 0x3f353f3500003f80,0x3f35bf353f800000,0x3f35bf353f808000,0xbf35bf350000bf80,0xbf6dbec40000bf80,0x3ec43f6dbf353f35,0xbec43f6dbf808000,0x3f6dbec43f353f35
.quad 0x3f353f3500003f80,0x3f35bf353f800000,0x3f35bf353f808000,0xbf35bf350000bf80,0xbf6dbec40000bf80,0x3ec43f6dbf353f35,0xbec43f6dbf808000,0x3f6dbec43f353f35
.quad 0x3f353f3500003f80,0x3f35bf353f800000,0x3f35bf353f808000,0xbf35bf350000bf80,0xbf6dbec40000bf80,0x3ec43f6dbf353f35,0xbec43f6dbf808000,0x3f6dbec43f353f35
.quad 0xbf35bf350000bf80,0xbf353f35bf800000,0xbf353f35bf808000,0x3f353f3500003f80,0x3ec4bf6d3f800000,0xbf6d3ec4bf35bf35,0xbf6dbec40000bf80,0x3ec43f6dbf353f35
.quad 0xbf35bf350000bf80,0xbf353f35bf800000,0xbf353f35bf808000,0x3f353f3500003f80,0x3ec4bf6d3f800000,0xbf6d3ec4bf35bf35,0xbf6dbec40000bf80,0x3ec43f6dbf353f35
.quad 0xbf35bf350000bf80,0xbf353f35bf800000,0xbf353f35bf808000,0x3f353f3500003f80,0x3ec4bf6d3f800000,0xbf6d3ec4bf35bf35,0xbf6dbec40000bf80,0x3ec43f6dbf353f35
.quad 0xbf35bf350000bf80,0xbf353f35bf800000,0xbf353f35bf808000,0x3f353f3500003f80,0x3ec4bf6d3f800000,0xbf6d3ec4bf35bf35,0xbf6dbec40000bf80,0x3ec43f6dbf353f35
.quad 0x3f353f3500003f80,0x3f35bf353f800000,0x3f35bf353f808000,0xbf35bf350000bf80,0x3f6d3ec400003f80,0xbec4bf6d3f35bf35,0x3ec4bf6d3f808000,0xbf6d3ec4bf35bf35
.quad 0x3f353f3500003f80,0x3f35bf353f800000,0x3f35bf353f808000,0xbf35bf350000bf80,0x3f6d3ec400003f80,0xbec4bf6d3f35bf35,0x3ec4bf6d3f808000,0xbf6d3ec4bf35bf35
.quad 0x3f353f3500003f80,0x3f35bf353f800000,0x3f35bf353f808000,0xbf35bf350000bf80,0x3f6d3ec400003f80,0xbec4bf6d3f35bf35,0x3ec4bf6d3f808000,0xbf6d3ec4bf35bf35
.quad 0x3f353f3500003f80,0x3f35bf353f800000,0x3f35bf353f808000,0xbf35bf350000bf80,0x3f6d3ec400003f80,0xbec4bf6d3f35bf35,0x3ec4bf6d3f808000,0xbf6d3ec4bf35bf35
.quad 0x3f80000000003f80,0xbf8000000000bf80,0xbf803f808000,0x3f80bf808000,0xbf6d3ec40000bf80,0x3ec4bf6d3f353f35,0x3ec43f6dbf808000,0xbf6dbec43f35bf35
.quad 0x3f80000000003f80,0xbf8000000000bf80,0xbf803f808000,0x3f80bf808000,0xbf6d3ec40000bf80,0x3ec4bf6d3f353f35,0x3ec43f6dbf808000,0xbf6dbec43f35bf35
.quad 0x3f80000000003f80,0xbf8000000000bf80,0xbf803f808000,0x3f80bf808000,0xbf6d3ec40000bf80,0x3ec4bf6d3f353f35,0x3ec43f6dbf808000,0xbf6dbec43f35bf35
.quad 0x3f80000000003f80,0xbf8000000000bf80,0xbf803f808000,0x3f80bf808000,0xbf6d3ec40000bf80,0x3ec4bf6d3f353f35,0x3ec43f6dbf808000,0xbf6dbec43f35bf35
.quad 0x3f80000000003f80,0xbf8000000000bf80,0xbf803f808000,0x3f80bf808000,0x3ec43f6dbf800000,0xbf6dbec43f35bf35,0x3f6dbec400003f80,0xbec43f6dbf35bf35
.quad 0x3f80000000003f80,0xbf8000000000bf80,0xbf803f808000,0x3f80bf808000,0x3ec43f6dbf800000,0xbf6dbec43f35bf35,0x3f6dbec400003f80,0xbec43f6dbf35bf35
.quad 0x3f80000000003f80,0xbf8000000000bf80,0xbf803f808000,0x3f80bf808000,0x3ec43f6dbf800000,0xbf6dbec43f35bf35,0x3f6dbec400003f80,0xbec43f6dbf35bf35
.quad 0x3f80000000003f80,0xbf8000000000bf80,0xbf803f808000,0x3f80bf808000,0x3ec43f6dbf800000,0xbf6dbec43f35bf35,0x3f6dbec400003f80,0xbec43f6dbf35bf35
.quad 0x3f80000000003f80,0xbf8000000000bf80,0xbf803f808000,0x3f80bf808000,0x3f6dbec400003f80,0xbec43f6dbf35bf35,0xbec4bf6d3f808000,0x3f6d3ec4bf353f35
.quad 0x3f80000000003f80,0xbf8000000000bf80,0xbf803f808000,0x3f80bf808000,0x3f6dbec400003f80,0xbec43f6dbf35bf35,0xbec4bf6d3f808000,0x3f6d3ec4bf353f35
.quad 0x3f80000000003f80,0xbf8000000000bf80,0xbf803f808000,0x3f80bf808000,0x3f6dbec400003f80,0xbec43f6dbf35bf35,0xbec4bf6d3f808000,0x3f6d3ec4bf353f35
.quad 0x3f80000000003f80,0xbf8000000000bf80,0xbf803f808000,0x3f80bf808000,0x3f6dbec400003f80,0xbec43f6dbf35bf35,0xbec4bf6d3f808000,0x3f6d3ec4bf353f35
.quad 0x3f80000000003f80,0xbf8000000000bf80,0xbf803f808000,0x3f80bf808000,0xbec4bf6d3f800000,0x3f6d3ec4bf353f35,0xbf6d3ec40000bf80,0x3ec4bf6d3f353f35
.quad 0x3f80000000003f80,0xbf8000000000bf80,0xbf803f808000,0x3f80bf808000,0xbec4bf6d3f800000,0x3f6d3ec4bf353f35,0xbf6d3ec40000bf80,0x3ec4bf6d3f353f35
.quad 0x3f80000000003f80,0xbf8000000000bf80,0xbf803f808000,0x3f80bf808000,0xbec4bf6d3f800000,0x3f6d3ec4bf353f35,0xbf6d3ec40000bf80,0x3ec4bf6d3f353f35
.quad 0x3f80000000003f80,0xbf8000000000bf80,0xbf803f808000,0x3f80bf808000,0xbec4bf6d3f800000,0x3f6d3ec4bf353f35,0xbf6d3ec40000bf80,0x3ec4bf6d3f353f35
.quad 0xbf353f350000bf80,0xbf35bf353f800000,0x3f353f35bf808000,0xbf353f350000bf80,0xbf6dbec43f800000,0xbec4bf6d3f353f35,0xbec43f6d0000bf80,0xbf6d3ec43f35bf35
.quad 0xbf353f350000bf80,0xbf35bf353f800000,0x3f353f35bf808000,0xbf353f350000bf80,0xbf6dbec43f800000,0xbec4bf6d3f353f35,0xbec43f6d0000bf80,0xbf6d3ec43f35bf35
.quad 0xbf353f350000bf80,0xbf35bf353f800000,0x3f353f35bf808000,0xbf353f350000bf80,0xbf6dbec43f800000,0xbec4bf6d3f353f35,0xbec43f6d0000bf80,0xbf6d3ec43f35bf35
.quad 0xbf353f350000bf80,0xbf35bf353f800000,0x3f353f35bf808000,0xbf353f350000bf80,0xbf6dbec43f800000,0xbec4bf6d3f353f35,0xbec43f6d0000bf80,0xbf6d3ec43f35bf35
.quad 0x3f35bf3500003f80,0x3f353f35bf800000,0xbf35bf353f808000,0x3f35bf3500003f80,0x3ec4bf6d00003f80,0x3f6dbec4bf353f35,0xbf6dbec43f808000,0xbec4bf6d3f353f35
.quad 0x3f35bf3500003f80,0x3f353f35bf800000,0xbf35bf353f808000,0x3f35bf3500003f80,0x3ec4bf6d00003f80,0x3f6dbec4bf353f35,0xbf6dbec43f808000,0xbec4bf6d3f353f35
.quad 0x3f35bf3500003f80,0x3f353f35bf800000,0xbf35bf353f808000,0x3f35bf3500003f80,0x3ec4bf6d00003f80,0x3f6dbec4bf353f35,0xbf6dbec43f808000,0xbec4bf6d3f353f35
.quad 0x3f35bf3500003f80,0x3f353f35bf800000,0xbf35bf353f808000,0x3f35bf3500003f80,0x3ec4bf6d00003f80,0x3f6dbec4bf353f35,0xbf6dbec43f808000,0xbec4bf6d3f353f35
.quad 0xbf353f350000bf80,0xbf35bf353f800000,0x3f353f35bf808000,0xbf353f350000bf80,0x3f6d3ec4bf800000,0x3ec43f6dbf35bf35,0x3ec4bf6d00003f80,0x3f6dbec4bf353f35
.quad 0xbf353f350000bf80,0xbf35bf353f800000,0x3f353f35bf808000,0xbf353f350000bf80,0x3f6d3ec4bf800000,0x3ec43f6dbf35bf35,0x3ec4bf6d00003f80,0x3f6dbec4bf353f35
.quad 0xbf353f350000bf80,0xbf35bf353f800000,0x3f353f35bf808000,0xbf353f350000bf80,0x3f6d3ec4bf800000,0x3ec43f6dbf35bf35,0x3ec4bf6d00003f80,0x3f6dbec4bf353f35
.quad 0xbf353f350000bf80,0xbf35bf353f800000,0x3f353f35bf808000,0xbf353f350000bf80,0x3f6d3ec4bf800000,0x3ec43f6dbf35bf35,0x3ec4bf6d00003f80,0x3f6dbec4bf353f35
.quad 0x3f35bf3500003f80,0x3f353f35bf800000,0xbf35bf353f808000,0x3f35bf3500003f80,0xbec43f6d0000bf80,0xbf6d3ec43f35bf35,0x3f6d3ec4bf808000,0x3ec43f6dbf35bf35
.quad 0x3f35bf3500003f80,0x3f353f35bf800000,0xbf35bf353f808000,0x3f35bf3500003f80,0xbec43f6d0000bf80,0xbf6d3ec43f35bf35,0x3f6d3ec4bf808000,0x3ec43f6dbf35bf35
.quad 0x3f35bf3500003f80,0x3f353f35bf800000,0xbf35bf353f808000,0x3f35bf3500003f80,0xbec43f6d0000bf80,0xbf6d3ec43f35bf35,0x3f6d3ec4bf808000,0x3ec43f6dbf35bf35
.quad 0x3f35bf3500003f80,0x3f353f35bf800000,0xbf35bf353f808000,0x3f35bf3500003f80,0xbec43f6d0000bf80,0xbf6d3ec43f35bf35,0x3f6d3ec4bf808000,0x3ec43f6dbf35bf35
.quad 0xbf8000003f80,0xbf8000003f80,0xbf8080003f808000,0xbf8080003f808000,0xbec4bf6d00003f80,0xbf6dbec43f353f35,0xbf6d3ec43f808000,0xbec43f6d3f35bf35
.quad 0xbf8000003f80,0xbf8000003f80,0xbf8080003f808000,0xbf8080003f808000,0xbec4bf6d00003f80,0xbf6dbec43f353f35,0xbf6d3ec43f808000,0xbec43f6d3f35bf35
.quad 0xbf8000003f80,0xbf8000003f80,0xbf8080003f808000,0xbf8080003f808000,0xbec4bf6d00003f80,0xbf6dbec43f353f35,0xbf6d3ec43f808000,0xbec43f6d3f35bf35
.quad 0xbf8000003f80,0xbf8000003f80,0xbf8080003f808000,0xbf8080003f808000,0xbec4bf6d00003f80,0xbf6dbec43f353f35,0xbf6d3ec43f808000,0xbec43f6d3f35bf35
.quad 0xbf8000003f80,0xbf8000003f80,0xbf8080003f808000,0xbf8080003f808000,0xbf6d3ec43f800000,0xbec43f6d3f35bf35,0x3ec43f6d0000bf80,0x3f6d3ec4bf35bf35
.quad 0xbf8000003f80,0xbf8000003f80,0xbf8080003f808000,0xbf8080003f808000,0xbf6d3ec43f800000,0xbec43f6d3f35bf35,0x3ec43f6d0000bf80,0x3f6d3ec4bf35bf35
.quad 0xbf8000003f80,0xbf8000003f80,0xbf8080003f808000,0xbf8080003f808000,0xbf6d3ec43f800000,0xbec43f6d3f35bf35,0x3ec43f6d0000bf80,0x3f6d3ec4bf35bf35
.quad 0xbf8000003f80,0xbf8000003f80,0xbf8080003f808000,0xbf8080003f808000,0xbf6d3ec43f800000,0xbec43f6d3f35bf35,0x3ec43f6d0000bf80,0x3f6d3ec4bf35bf35
.quad 0xbf8000003f80,0xbf8000003f80,0xbf8080003f808000,0xbf8080003f808000,0x3ec43f6d0000bf80,0x3f6d3ec4bf35bf35,0x3f6dbec4bf808000,0x3ec4bf6dbf353f35
.quad 0xbf8000003f80,0xbf8000003f80,0xbf8080003f808000,0xbf8080003f808000,0x3ec43f6d0000bf80,0x3f6d3ec4bf35bf35,0x3f6dbec4bf808000,0x3ec4bf6dbf353f35
.quad 0xbf8000003f80,0xbf8000003f80,0xbf8080003f808000,0xbf8080003f808000,0x3ec43f6d0000bf80,0x3f6d3ec4bf35bf35,0x3f6dbec4bf808000,0x3ec4bf6dbf353f35
.quad 0xbf8000003f80,0xbf8000003f80,0xbf8080003f808000,0xbf8080003f808000,0x3ec43f6d0000bf80,0x3f6d3ec4bf35bf35,0x3f6dbec4bf808000,0x3ec4bf6dbf353f35
.quad 0xbf8000003f80,0xbf8000003f80,0xbf8080003f808000,0xbf8080003f808000,0x3f6dbec4bf800000,0x3ec4bf6dbf353f35,0xbec4bf6d00003f80,0xbf6dbec43f353f35
.quad 0xbf8000003f80,0xbf8000003f80,0xbf8080003f808000,0xbf8080003f808000,0x3f6dbec4bf800000,0x3ec4bf6dbf353f35,0xbec4bf6d00003f80,0xbf6dbec43f353f35
.quad 0xbf8000003f80,0xbf8000003f80,0xbf8080003f808000,0xbf8080003f808000,0x3f6dbec4bf800000,0x3ec4bf6dbf353f35,0xbec4bf6d00003f80,0xbf6dbec43f353f35
.quad 0xbf8000003f80,0xbf8000003f80,0xbf8080003f808000,0xbf8080003f808000,0x3f6dbec4bf800000,0x3ec4bf6dbf353f35,0xbec4bf6d00003f80,0xbf6dbec43f353f35
.quad 0x3f353f350000bf80,0x3f35bf35bf800000,0x3f35bf35bf808000,0xbf35bf3500003f80,0x3ec4bf6dbf800000,0xbf6d3ec43f353f35,0xbf6dbec400003f80,0x3ec43f6d3f35bf35
.quad 0x3f353f350000bf80,0x3f35bf35bf800000,0x3f35bf35bf808000,0xbf35bf3500003f80,0x3ec4bf6dbf800000,0xbf6d3ec43f353f35,0xbf6dbec400003f80,0x3ec43f6d3f35bf35
.quad 0x3f353f350000bf80,0x3f35bf35bf800000,0x3f35bf35bf808000,0xbf35bf3500003f80,0x3ec4bf6dbf800000,0xbf6d3ec43f353f35,0xbf6dbec400003f80,0x3ec43f6d3f35bf35
.quad 0x3f353f350000bf80,0x3f35bf35bf800000,0x3f35bf35bf808000,0xbf35bf3500003f80,0x3ec4bf6dbf800000,0xbf6d3ec43f353f35,0xbf6dbec400003f80,0x3ec43f6d3f35bf35
.quad 0xbf35bf3500003f80,0xbf353f353f800000,0xbf353f353f808000,0x3f353f350000bf80,0x3f6d3ec40000bf80,0xbec4bf6dbf353f35,0x3ec4bf6dbf808000,0xbf6d3ec43f353f35
.quad 0xbf35bf3500003f80,0xbf353f353f800000,0xbf353f353f808000,0x3f353f350000bf80,0x3f6d3ec40000bf80,0xbec4bf6dbf353f35,0x3ec4bf6dbf808000,0xbf6d3ec43f353f35
.quad 0xbf35bf3500003f80,0xbf353f353f800000,0xbf353f353f808000,0x3f353f350000bf80,0x3f6d3ec40000bf80,0xbec4bf6dbf353f35,0x3ec4bf6dbf808000,0xbf6d3ec43f353f35
.quad 0xbf35bf3500003f80,0xbf353f353f800000,0xbf353f353f808000,0x3f353f350000bf80,0x3f6d3ec40000bf80,0xbec4bf6dbf353f35,0x3ec4bf6dbf808000,0xbf6d3ec43f353f35
.quad 0x3f353f350000bf80,0x3f35bf35bf800000,0x3f35bf35bf808000,0xbf35bf3500003f80,0xbec43f6d3f800000,0x3f6dbec4bf35bf35,0x3f6d3ec40000bf80,0xbec4bf6dbf353f35
.quad 0x3f353f350000bf80,0x3f35bf35bf800000,0x3f35bf35bf808000,0xbf35bf3500003f80,0xbec43f6d3f800000,0x3f6dbec4bf35bf35,0x3f6d3ec40000bf80,0xbec4bf6dbf353f35
.quad 0x3f353f350000bf80,0x3f35bf35bf800000,0x3f35bf35bf808000,0xbf35bf3500003f80,0xbec43f6d3f800000,0x3f6dbec4bf35bf35,0x3f6d3ec40000bf80,0xbec4bf6dbf353f35
.quad 0x3f353f350000bf80,0x3f35bf35bf800000,0x3f35bf35bf808000,0xbf35bf3500003f80,0xbec43f6d3f800000,0x3f6dbec4bf35bf35,0x3f6d3ec40000bf80,0xbec4bf6dbf353f35
.quad 0xbf35bf3500003f80,0xbf353f353f800000,0xbf353f353f808000,0x3f353f350000bf80,0xbf6dbec400003f80,0x3ec43f6d3f35bf35,0xbec43f6d3f808000,0x3f6dbec4bf35bf35
.quad 0xbf35bf3500003f80,0xbf353f353f800000,0xbf353f353f808000,0x3f353f350000bf80,0xbf6dbec400003f80,0x3ec43f6d3f35bf35,0xbec43f6d3f808000,0x3f6dbec4bf35bf35
.quad 0xbf35bf3500003f80,0xbf353f353f800000,0xbf353f353f808000,0x3f353f350000bf80,0xbf6dbec400003f80,0x3ec43f6d3f35bf35,0xbec43f6d3f808000,0x3f6dbec4bf35bf35
.quad 0xbf35bf3500003f80,0xbf353f353f800000,0xbf353f353f808000,0x3f353f350000bf80,0xbf6dbec400003f80,0x3ec43f6d3f35bf35,0xbec43f6d3f808000,0x3f6dbec4bf35bf35
.quad 0xbf80000000003f80,0x3f8000000000bf80,0x3f803f808000,0xbf80bf808000,0x3f6dbec40000bf80,0xbec43f6d3f353f35,0xbec4bf6dbf808000,0x3f6d3ec43f35bf35
.quad 0xbf80000000003f80,0x3f8000000000bf80,0x3f803f808000,0xbf80bf808000,0x3f6dbec40000bf80,0xbec43f6d3f353f35,0xbec4bf6dbf808000,0x3f6d3ec43f35bf35
.quad 0xbf80000000003f80,0x3f8000000000bf80,0x3f803f808000,0xbf80bf808000,0x3f6dbec40000bf80,0xbec43f6d3f353f35,0xbec4bf6dbf808000,0x3f6d3ec43f35bf35
.quad 0xbf80000000003f80,0x3f8000000000bf80,0x3f803f808000,0xbf80bf808000,0x3f6dbec40000bf80,0xbec43f6d3f353f35,0xbec4bf6dbf808000,0x3f6d3ec43f35bf35
.quad 0xbf80000000003f80,0x3f8000000000bf80,0x3f803f808000,0xbf80bf808000,0xbec4bf6dbf800000,0x3f6d3ec43f35bf35,0xbf6d3ec400003f80,0x3ec4bf6dbf35bf35
.quad 0xbf80000000003f80,0x3f8000000000bf80,0x3f803f808000,0xbf80bf808000,0xbec4bf6dbf800000,0x3f6d3ec43f35bf35,0xbf6d3ec400003f80,0x3ec4bf6dbf35bf35
.quad 0xbf80000000003f80,0x3f8000000000bf80,0x3f803f808000,0xbf80bf808000,0xbec4bf6dbf800000,0x3f6d3ec43f35bf35,0xbf6d3ec400003f80,0x3ec4bf6dbf35bf35
.quad 0xbf80000000003f80,0x3f8000000000bf80,0x3f803f808000,0xbf80bf808000,0xbec4bf6dbf800000,0x3f6d3ec43f35bf35,0xbf6d3ec400003f80,0x3ec4bf6dbf35bf35
.quad 0xbf80000000003f80,0x3f8000000000bf80,0x3f803f808000,0xbf80bf808000,0xbf6d3ec400003f80,0x3ec4bf6dbf35bf35,0x3ec43f6d3f808000,0xbf6dbec4bf353f35
.quad 0xbf80000000003f80,0x3f8000000000bf80,0x3f803f808000,0xbf80bf808000,0xbf6d3ec400003f80,0x3ec4bf6dbf35bf35,0x3ec43f6d3f808000,0xbf6dbec4bf353f35
.quad 0xbf80000000003f80,0x3f8000000000bf80,0x3f803f808000,0xbf80bf808000,0xbf6d3ec400003f80,0x3ec4bf6dbf35bf35,0x3ec43f6d3f808000,0xbf6dbec4bf353f35
.quad 0xbf80000000003f80,0x3f8000000000bf80,0x3f803f808000,0xbf80bf808000,0xbf6d3ec400003f80,0x3ec4bf6dbf35bf35,0x3ec43f6d3f808000,0xbf6dbec4bf353f35
.quad 0xbf80000000003f80,0x3f8000000000bf80,0x3f803f808000,0xbf80bf808000,0x3ec43f6d3f800000,0xbf6dbec4bf353f35,0x3f6dbec40000bf80,0xbec43f6d3f353f35
.quad 0xbf80000000003f80,0x3f8000000000bf80,0x3f803f808000,0xbf80bf808000,0x3ec43f6d3f800000,0xbf6dbec4bf353f35,0x3f6dbec40000bf80,0xbec43f6d3f353f35
.quad 0xbf80000000003f80,0x3f8000000000bf80,0x3f803f808000,0xbf80bf808000,0x3ec43f6d3f800000,0xbf6dbec4bf353f35,0x3f6dbec40000bf80,0xbec43f6d3f353f35
.quad 0xbf80000000003f80,0x3f8000000000bf80,0x3f803f808000,0xbf80bf808000,0x3ec43f6d3f800000,0xbf6dbec4bf353f35,0x3f6dbec40000bf80,0xbec43f6d3f353f35
.quad 0x3f35bf350000bf80,0x3f353f353f800000,0xbf35bf35bf808000,0x3f35bf350000bf80,0x3f6d3ec43f800000,0x3ec43f6d3f353f35,0x3ec4bf6d0000bf80,0x3f6dbec43f35bf35
.quad 0x3f35bf350000bf80,0x3f353f353f800000,0xbf35bf35bf808000,0x3f35bf350000bf80,0x3f6d3ec43f800000,0x3ec43f6d3f353f35,0x3ec4bf6d0000bf80,0x3f6dbec43f35bf35
.quad 0x3f35bf350000bf80,0x3f353f353f800000,0xbf35bf35bf808000,0x3f35bf350000bf80,0x3f6d3ec43f800000,0x3ec43f6d3f353f35,0x3ec4bf6d0000bf80,0x3f6dbec43f35bf35
.quad 0x3f35bf350000bf80,0x3f353f353f800000,0xbf35bf35bf808000,0x3f35bf350000bf80,0x3f6d3ec43f800000,0x3ec43f6d3f353f35,0x3ec4bf6d0000bf80,0x3f6dbec43f35bf35
.quad 0xbf353f3500003f80,0xbf35bf35bf800000,0x3f353f353f808000,0xbf353f3500003f80,0xbec43f6d00003f80,0xbf6d3ec4bf353f35,0x3f6d3ec43f808000,0x3ec43f6d3f353f35
.quad 0xbf353f3500003f80,0xbf35bf35bf800000,0x3f353f353f808000,0xbf353f3500003f80,0xbec43f6d00003f80,0xbf6d3ec4bf353f35,0x3f6d3ec43f808000,0x3ec43f6d3f353f35
.quad 0xbf353f3500003f80,0xbf35bf35bf800000,0x3f353f353f808000,0xbf353f3500003f80,0xbec43f6d00003f80,0xbf6d3ec4bf353f35,0x3f6d3ec43f808000,0x3ec43f6d3f353f35
.quad 0xbf353f3500003f80,0xbf35bf35bf800000,0x3f353f353f808000,0xbf353f3500003f80,0xbec43f6d00003f80,0xbf6d3ec4bf353f35,0x3f6d3ec43f808000,0x3ec43f6d3f353f35
.quad 0x3f35bf350000bf80,0x3f353f353f800000,0xbf35bf35bf808000,0x3f35bf350000bf80,0xbf6dbec4bf800000,0xbec4bf6dbf35bf35,0xbec43f6d00003f80,0xbf6d3ec4bf353f35
.quad 0x3f35bf350000bf80,0x3f353f353f800000,0xbf35bf35bf808000,0x3f35bf350000bf80,0xbf6dbec4bf800000,0xbec4bf6dbf35bf35,0xbec43f6d00003f80,0xbf6d3ec4bf353f35
.quad 0x3f35bf350000bf80,0x3f353f353f800000,0xbf35bf35bf808000,0x3f35bf350000bf80,0xbf6dbec4bf800000,0xbec4bf6dbf35bf35,0xbec43f6d00003f80,0xbf6d3ec4bf353f35
.quad 0x3f35bf350000bf80,0x3f353f353f800000,0xbf35bf35bf808000,0x3f35bf350000bf80,0xbf6dbec4bf800000,0xbec4bf6dbf35bf35,0xbec43f6d00003f80,0xbf6d3ec4bf353f35
.quad 0xbf353f3500003f80,0xbf35bf35bf800000,0x3f353f353f808000,0xbf353f3500003f80,0x3ec4bf6d0000bf80,0x3f6dbec43f35bf35,0xbf6dbec4bf808000,0xbec4bf6dbf35bf35
.quad 0xbf353f3500003f80,0xbf35bf35bf800000,0x3f353f353f808000,0xbf353f3500003f80,0x3ec4bf6d0000bf80,0x3f6dbec43f35bf35,0xbf6dbec4bf808000,0xbec4bf6dbf35bf35
.quad 0xbf353f3500003f80,0xbf35bf35bf800000,0x3f353f353f808000,0xbf353f3500003f80,0x3ec4bf6d0000bf80,0x3f6dbec43f35bf35,0xbf6dbec4bf808000,0xbec4bf6dbf35bf35
.quad 0xbf353f3500003f80,0xbf35bf35bf800000,0x3f353f353f808000,0xbf353f3500003f80,0x3ec4bf6d0000bf80,0x3f6dbec43f35bf35,0xbf6dbec4bf808000,0xbec4bf6dbf35bf35
.quad 0x3f6d00003f80,0x3ec400003f35,0xbec400008000,0xbf6d0000bf35,0x3f3500003f80,0xbf3500000000,0xbf3500008000,0xbf350000bf80
.quad 0x3f6d00003f80,0x3ec400003f35,0xbec400008000,0xbf6d0000bf35,0x3f3500003f80,0xbf3500000000,0xbf3500008000,0xbf350000bf80
.quad 0x3f6d00003f80,0x3ec400003f35,0xbec400008000,0xbf6d0000bf35,0x3f3500003f80,0xbf3500000000,0xbf3500008000,0xbf350000bf80
.quad 0x3f6d00003f80,0x3ec400003f35,0xbec400008000,0xbf6d0000bf35,0x3f3500003f80,0xbf3500000000,0xbf3500008000,0xbf350000bf80
.quad 0xbec400000000,0xbf6d0000bf35,0xbf6d0000bf80,0xbec40000bf35,0xbf350000bf80,0x3f3500000000,0x3f3500008000,0x3f3500003f80
.quad 0xbec400000000,0xbf6d0000bf35,0xbf6d0000bf80,0xbec40000bf35,0xbf350000bf80,0x3f3500000000,0x3f3500008000,0x3f3500003f80
.quad 0xbec400000000,0xbf6d0000bf35,0xbf6d0000bf80,0xbec40000bf35,0xbf350000bf80,0x3f3500000000,0x3f3500008000,0x3f3500003f80
.quad 0xbec400000000,0xbf6d0000bf35,0xbf6d0000bf80,0xbec40000bf35,0xbf350000bf80,0x3f3500000000,0x3f3500008000,0x3f3500003f80
.quad 0xbf6d0000bf80,0xbec40000bf35,0x3ec400008000,0x3f6d00003f35,0x3f3500003f80,0xbf3500000000,0xbf3500008000,0xbf350000bf80
.quad 0xbf6d0000bf80,0xbec40000bf35,0x3ec400008000,0x3f6d00003f35,0x3f3500003f80,0xbf3500000000,0xbf3500008000,0xbf350000bf80
.quad 0xbf6d0000bf80,0xbec40000bf35,0x3ec400008000,0x3f6d00003f35,0x3f3500003f80,0xbf3500000000,0xbf3500008000,0xbf350000bf80
.quad 0xbf6d0000bf80,0xbec40000bf35,0x3ec400008000,0x3f6d00003f35,0x3f3500003f80,0xbf3500000000,0xbf3500008000,0xbf350000bf80
.quad 0x3ec400000000,0x3f6d00003f35,0x3f6d00003f80,0x3ec400003f35,0xbf350000bf80,0x3f3500000000,0x3f3500008000,0x3f3500003f80
.quad 0x3ec400000000,0x3f6d00003f35,0x3f6d00003f80,0x3ec400003f35,0xbf350000bf80,0x3f3500000000,0x3f3500008000,0x3f3500003f80
.quad 0x3ec400000000,0x3f6d00003f35,0x3f6d00003f80,0x3ec400003f35,0xbf350000bf80,0x3f3500000000,0x3f3500008000,0x3f3500003f80
.quad 0x3ec400000000,0x3f6d00003f35,0x3f6d00003f80,0x3ec400003f35,0xbf350000bf80,0x3f3500000000,0x3f3500008000,0x3f3500003f80
.quad 0x3f6d00000000,0xbec400003f35,0x3ec400003f80,0xbf6d0000bf35,0x3f80,0xbf80,0xbf8000008000,0x3f8000008000
.quad 0x3f6d00000000,0xbec400003f35,0x3ec400003f80,0xbf6d0000bf35,0x3f80,0xbf80,0xbf8000008000,0x3f8000008000
.quad 0x3f6d00000000,0xbec400003f35,0x3ec400003f80,0xbf6d0000bf35,0x3f80,0xbf80,0xbf8000008000,0x3f8000008000
.quad 0x3f6d00000000,0xbec400003f35,0x3ec400003f80,0xbf6d0000bf35,0x3f80,0xbf80,0xbf8000008000,0x3f8000008000
.quad 0xbec40000bf80,0x3f6d00003f35,0x3f6d00008000,0xbec400003f35,0x3f80,0xbf80,0xbf8000008000,0x3f8000008000
.quad 0xbec40000bf80,0x3f6d00003f35,0x3f6d00008000,0xbec400003f35,0x3f80,0xbf80,0xbf8000008000,0x3f8000008000
.quad 0xbec40000bf80,0x3f6d00003f35,0x3f6d00008000,0xbec400003f35,0x3f80,0xbf80,0xbf8000008000,0x3f8000008000
.quad 0xbec40000bf80,0x3f6d00003f35,0x3f6d00008000,0xbec400003f35,0x3f80,0xbf80,0xbf8000008000,0x3f8000008000
.quad 0xbf6d00000000,0x3ec40000bf35,0xbec40000bf80,0x3f6d00003f35,0x3f80,0xbf80,0xbf8000008000,0x3f8000008000
.quad 0xbf6d00000000,0x3ec40000bf35,0xbec40000bf80,0x3f6d00003f35,0x3f80,0xbf80,0xbf8000008000,0x3f8000008000
.quad 0xbf6d00000000,0x3ec40000bf35,0xbec40000bf80,0x3f6d00003f35,0x3f80,0xbf80,0xbf8000008000,0x3f8000008000
.quad 0xbf6d00000000,0x3ec40000bf35,0xbec40000bf80,0x3f6d00003f35,0x3f80,0xbf80,0xbf8000008000,0x3f8000008000
.quad 0x3ec400003f80,0xbf6d0000bf35,0xbf6d00008000,0x3ec40000bf35,0x3f80,0xbf80,0xbf8000008000,0x3f8000008000
.quad 0x3ec400003f80,0xbf6d0000bf35,0xbf6d00008000,0x3ec40000bf35,0x3f80,0xbf80,0xbf8000008000,0x3f8000008000
.quad 0x3ec400003f80,0xbf6d0000bf35,0xbf6d00008000,0x3ec40000bf35,0x3f80,0xbf80,0xbf8000008000,0x3f8000008000
.quad 0x3ec400003f80,0xbf6d0000bf35,0xbf6d00008000,0x3ec40000bf35,0x3f80,0xbf80,0xbf8000008000,0x3f8000008000
.quad 0x3ec40000bf80,0xbf6d00003f35,0x3f6d00008000,0xbec40000bf35,0xbf3500003f80,0x3f3500000000,0xbf3500008000,0xbf3500003f80
.quad 0x3ec40000bf80,0xbf6d00003f35,0x3f6d00008000,0xbec40000bf35,0xbf3500003f80,0x3f3500000000,0xbf3500008000,0xbf3500003f80
.quad 0x3ec40000bf80,0xbf6d00003f35,0x3f6d00008000,0xbec40000bf35,0xbf3500003f80,0x3f3500000000,0xbf3500008000,0xbf3500003f80
.quad 0x3ec40000bf80,0xbf6d00003f35,0x3f6d00008000,0xbec40000bf35,0xbf3500003f80,0x3f3500000000,0xbf3500008000,0xbf3500003f80
.quad 0x3f6d00000000,0xbec40000bf35,0xbec400003f80,0x3f6d0000bf35,0x3f350000bf80,0xbf3500000000,0x3f3500008000,0x3f350000bf80
.quad 0x3f6d00000000,0xbec40000bf35,0xbec400003f80,0x3f6d0000bf35,0x3f350000bf80,0xbf3500000000,0x3f3500008000,0x3f350000bf80
.quad 0x3f6d00000000,0xbec40000bf35,0xbec400003f80,0x3f6d0000bf35,0x3f350000bf80,0xbf3500000000,0x3f3500008000,0x3f350000bf80
.quad 0x3f6d00000000,0xbec40000bf35,0xbec400003f80,0x3f6d0000bf35,0x3f350000bf80,0xbf3500000000,0x3f3500008000,0x3f350000bf80
.quad 0xbec400003f80,0x3f6d0000bf35,0xbf6d00008000,0x3ec400003f35,0xbf3500003f80,0x3f3500000000,0xbf3500008000,0xbf3500003f80
.quad 0xbec400003f80,0x3f6d0000bf35,0xbf6d00008000,0x3ec400003f35,0xbf3500003f80,0x3f3500000000,0xbf3500008000,0xbf3500003f80
.quad 0xbec400003f80,0x3f6d0000bf35,0xbf6d00008000,0x3ec400003f35,0xbf3500003f80,0x3f3500000000,0xbf3500008000,0xbf3500003f80
.quad 0xbec400003f80,0x3f6d0000bf35,0xbf6d00008000,0x3ec400003f35,0xbf3500003f80,0x3f3500000000,0xbf3500008000,0xbf3500003f80
.quad 0xbf6d00000000,0x3ec400003f35,0x3ec40000bf80,0xbf6d00003f35,0x3f350000bf80,0xbf3500000000,0x3f3500008000,0x3f350000bf80
.quad 0xbf6d00000000,0x3ec400003f35,0x3ec40000bf80,0xbf6d00003f35,0x3f350000bf80,0xbf3500000000,0x3f3500008000,0x3f350000bf80
.quad 0xbf6d00000000,0x3ec400003f35,0x3ec40000bf80,0xbf6d00003f35,0x3f350000bf80,0xbf3500000000,0x3f3500008000,0x3f350000bf80
.quad 0xbf6d00000000,0x3ec400003f35,0x3ec40000bf80,0xbf6d00003f35,0x3f350000bf80,0xbf3500000000,0x3f3500008000,0x3f350000bf80
.quad 0xbec400000000,0xbf6d00003f35,0x3f6d0000bf80,0x3ec40000bf35,0x3f8000003f80,0x3f8000003f80,0x800000008000,0x800000008000
.quad 0xbec400000000,0xbf6d00003f35,0x3f6d0000bf80,0x3ec40000bf35,0x3f8000003f80,0x3f8000003f80,0x800000008000,0x800000008000
.quad 0xbec400000000,0xbf6d00003f35,0x3f6d0000bf80,0x3ec40000bf35,0x3f8000003f80,0x3f8000003f80,0x800000008000,0x800000008000
.quad 0xbec400000000,0xbf6d00003f35,0x3f6d0000bf80,0x3ec40000bf35,0x3f8000003f80,0x3f8000003f80,0x800000008000,0x800000008000
.quad 0xbf6d00003f80,0xbec400003f35,0xbec400008000,0xbf6d00003f35,0x3f8000003f80,0x3f8000003f80,0x800000008000,0x800000008000
.quad 0xbf6d00003f80,0xbec400003f35,0xbec400008000,0xbf6d00003f35,0x3f8000003f80,0x3f8000003f80,0x800000008000,0x800000008000
.quad 0xbf6d00003f80,0xbec400003f35,0xbec400008000,0xbf6d00003f35,0x3f8000003f80,0x3f8000003f80,0x800000008000,0x800000008000
.quad 0xbf6d00003f80,0xbec400003f35,0xbec400008000,0xbf6d00003f35,0x3f8000003f80,0x3f8000003f80,0x800000008000,0x800000008000
.quad 0x3ec400000000,0x3f6d0000bf35,0xbf6d00003f80,0xbec400003f35,0x3f8000003f80,0x3f8000003f80,0x800000008000,0x800000008000
.quad 0x3ec400000000,0x3f6d0000bf35,0xbf6d00003f80,0xbec400003f35,0x3f8000003f80,0x3f8000003f80,0x800000008000,0x800000008000
.quad 0x3ec400000000,0x3f6d0000bf35,0xbf6d00003f80,0xbec400003f35,0x3f8000003f80,0x3f8000003f80,0x800000008000,0x800000008000
.quad 0x3ec400000000,0x3f6d0000bf35,0xbf6d00003f80,0xbec400003f35,0x3f8000003f80,0x3f8000003f80,0x800000008000,0x800000008000
.quad 0x3f6d0000bf80,0x3ec40000bf35,0x3ec400008000,0x3f6d0000bf35,0x3f8000003f80,0x3f8000003f80,0x800000008000,0x800000008000
.quad 0x3f6d0000bf80,0x3ec40000bf35,0x3ec400008000,0x3f6d0000bf35,0x3f8000003f80,0x3f8000003f80,0x800000008000,0x800000008000
.quad 0x3f6d0000bf80,0x3ec40000bf35,0x3ec400008000,0x3f6d0000bf35,0x3f8000003f80,0x3f8000003f80,0x800000008000,0x800000008000
.quad 0x3f6d0000bf80,0x3ec40000bf35,0x3ec400008000,0x3f6d0000bf35,0x3f8000003f80,0x3f8000003f80,0x800000008000,0x800000008000
.quad 0x3f7b00003f800000,0x3f5500003f6d0000,0xbe48000080000000,0xbf0e0000bec40000,0x3f5500003f800000,0xbe4800003ec40000,0xbf0e000080000000,0xbf7b0000bf6d0000
.quad 0x3f7b00003f800000,0x3f5500003f6d0000,0xbe48000080000000,0xbf0e0000bec40000,0x3f5500003f800000,0xbe4800003ec40000,0xbf0e000080000000,0xbf7b0000bf6d0000
.quad 0x3f7b00003f800000,0x3f5500003f6d0000,0xbe48000080000000,0xbf0e0000bec40000,0x3f5500003f800000,0xbe4800003ec40000,0xbf0e000080000000,0xbf7b0000bf6d0000
.quad 0x3f7b00003f800000,0x3f5500003f6d0000,0xbe48000080000000,0xbf0e0000bec40000,0x3f5500003f800000,0xbe4800003ec40000,0xbf0e000080000000,0xbf7b0000bf6d0000
.quad 0x3f0e00003f350000,0x3e4800003ec40000,0xbf550000bf350000,0xbf7b0000bf6d0000,0xbf7b0000bf350000,0xbf0e0000bf6d0000,0xbe480000bf350000,0x3f5500003ec40000
.quad 0x3f0e00003f350000,0x3e4800003ec40000,0xbf550000bf350000,0xbf7b0000bf6d0000,0xbf7b0000bf350000,0xbf0e0000bf6d0000,0xbe480000bf350000,0x3f5500003ec40000
.quad 0x3f0e00003f350000,0x3e4800003ec40000,0xbf550000bf350000,0xbf7b0000bf6d0000,0xbf7b0000bf350000,0xbf0e0000bf6d0000,0xbe480000bf350000,0x3f5500003ec40000
.quad 0x3f0e00003f350000,0x3e4800003ec40000,0xbf550000bf350000,0xbf7b0000bf6d0000,0xbf7b0000bf350000,0xbf0e0000bf6d0000,0xbe480000bf350000,0x3f5500003ec40000
.quad 0xbe48000000000000,0xbf0e0000bec40000,0xbf7b0000bf800000,0xbf550000bf6d0000,0x3f0e000000000000,0x3f7b00003f6d0000,0x3f5500003f800000,0xbe4800003ec40000
.quad 0xbe48000000000000,0xbf0e0000bec40000,0xbf7b0000bf800000,0xbf550000bf6d0000,0x3f0e000000000000,0x3f7b00003f6d0000,0x3f5500003f800000,0xbe4800003ec40000
.quad 0xbe48000000000000,0xbf0e0000bec40000,0xbf7b0000bf800000,0xbf550000bf6d0000,0x3f0e000000000000,0x3f7b00003f6d0000,0x3f5500003f800000,0xbe4800003ec40000
.quad 0xbe48000000000000,0xbf0e0000bec40000,0xbf7b0000bf800000,0xbf550000bf6d0000,0x3f0e000000000000,0x3f7b00003f6d0000,0x3f5500003f800000,0xbe4800003ec40000
.quad 0xbf550000bf350000,0xbf7b0000bf6d0000,0xbf0e0000bf350000,0xbe480000bec40000,0x3e4800003f350000,0xbf550000bec40000,0xbf7b0000bf350000,0xbf0e0000bf6d0000
.quad 0xbf550000bf350000,0xbf7b0000bf6d0000,0xbf0e0000bf350000,0xbe480000bec40000,0x3e4800003f350000,0xbf550000bec40000,0xbf7b0000bf350000,0xbf0e0000bf6d0000
.quad 0xbf550000bf350000,0xbf7b0000bf6d0000,0xbf0e0000bf350000,0xbe480000bec40000,0x3e4800003f350000,0xbf550000bec40000,0xbf7b0000bf350000,0xbf0e0000bf6d0000
.quad 0xbf550000bf350000,0xbf7b0000bf6d0000,0xbf0e0000bf350000,0xbe480000bec40000,0x3e4800003f350000,0xbf550000bec40000,0xbf7b0000bf350000,0xbf0e0000bf6d0000
.quad 0x3e480000bf350000,0x3f5500003f6d0000,0x3f7b00003f350000,0xbf0e00003ec40000,0x3f5500003f350000,0xbf7b0000bec40000,0xbf0e00003f350000,0x3e480000bf6d0000
.quad 0x3e480000bf350000,0x3f5500003f6d0000,0x3f7b00003f350000,0xbf0e00003ec40000,0x3f5500003f350000,0xbf7b0000bec40000,0xbf0e00003f350000,0x3e480000bf6d0000
.quad 0x3e480000bf350000,0x3f5500003f6d0000,0x3f7b00003f350000,0xbf0e00003ec40000,0x3f5500003f350000,0xbf7b0000bec40000,0xbf0e00003f350000,0x3e480000bf6d0000
.quad 0x3e480000bf350000,0x3f5500003f6d0000,0x3f7b00003f350000,0xbf0e00003ec40000,0x3f5500003f350000,0xbf7b0000bec40000,0xbf0e00003f350000,0x3e480000bf6d0000
.quad 0xbf55000000000000,0xbe480000bf6d0000,0xbf0e0000bf800000,0x3f7b00003ec40000,0x3f7b000000000000,0xbf5500003ec40000,0x3e4800003f800000,0xbf0e0000bf6d0000
.quad 0xbf55000000000000,0xbe480000bf6d0000,0xbf0e0000bf800000,0x3f7b00003ec40000,0x3f7b000000000000,0xbf5500003ec40000,0x3e4800003f800000,0xbf0e0000bf6d0000
.quad 0xbf55000000000000,0xbe480000bf6d0000,0xbf0e0000bf800000,0x3f7b00003ec40000,0x3f7b000000000000,0xbf5500003ec40000,0x3e4800003f800000,0xbf0e0000bf6d0000
.quad 0xbf55000000000000,0xbe480000bf6d0000,0xbf0e0000bf800000,0x3f7b00003ec40000,0x3f7b000000000000,0xbf5500003ec40000,0x3e4800003f800000,0xbf0e0000bf6d0000
.quad 0x3f7b00003f350000,0xbf0e00003ec40000,0xbe4800003f350000,0xbf550000bf6d0000,0x3f0e0000bf350000,0xbe4800003f6d0000,0x3f5500003f350000,0xbf7b0000bec40000
.quad 0x3f7b00003f350000,0xbf0e00003ec40000,0xbe4800003f350000,0xbf550000bf6d0000,0x3f0e0000bf350000,0xbe4800003f6d0000,0x3f5500003f350000,0xbf7b0000bec40000
.quad 0x3f7b00003f350000,0xbf0e00003ec40000,0xbe4800003f350000,0xbf550000bf6d0000,0x3f0e0000bf350000,0xbe4800003f6d0000,0x3f5500003f350000,0xbf7b0000bec40000
.quad 0x3f7b00003f350000,0xbf0e00003ec40000,0xbe4800003f350000,0xbf550000bf6d0000,0x3f0e0000bf350000,0xbe4800003f6d0000,0x3f5500003f350000,0xbf7b0000bec40000
.quad 0x3f0e00003f800000,0xbf7b0000bec40000,0xbf55000080000000,0xbe480000bf6d0000,0x3e4800003f800000,0xbf0e0000bf6d0000,0xbf7b000080000000,0x3f550000bec40000
.quad 0x3f0e00003f800000,0xbf7b0000bec40000,0xbf55000080000000,0xbe480000bf6d0000,0x3e4800003f800000,0xbf0e0000bf6d0000,0xbf7b000080000000,0x3f550000bec40000
.quad 0x3f0e00003f800000,0xbf7b0000bec40000,0xbf55000080000000,0xbe480000bf6d0000,0x3e4800003f800000,0xbf0e0000bf6d0000,0xbf7b000080000000,0x3f550000bec40000
.quad 0x3f0e00003f800000,0xbf7b0000bec40000,0xbf55000080000000,0xbe480000bf6d0000,0x3e4800003f800000,0xbf0e0000bf6d0000,0xbf7b000080000000,0x3f550000bec40000
.quad 0xbf7b000000000000,0x3f5500003ec40000,0x3e480000bf800000,0xbf0e00003f6d0000,0x3f55000000000000,0x3e480000bf6d0000,0xbf0e00003f800000,0x3f7b0000bec40000
.quad 0xbf7b000000000000,0x3f5500003ec40000,0x3e480000bf800000,0xbf0e00003f6d0000,0x3f55000000000000,0x3e480000bf6d0000,0xbf0e00003f800000,0x3f7b0000bec40000
.quad 0xbf7b000000000000,0x3f5500003ec40000,0x3e480000bf800000,0xbf0e00003f6d0000,0x3f55000000000000,0x3e480000bf6d0000,0xbf0e00003f800000,0x3f7b0000bec40000
.quad 0xbf7b000000000000,0x3f5500003ec40000,0x3e480000bf800000,0xbf0e00003f6d0000,0x3f55000000000000,0x3e480000bf6d0000,0xbf0e00003f800000,0x3f7b0000bec40000
.quad 0xbf0e0000bf350000,0x3e4800003f6d0000,0x3f550000bf350000,0xbf7b00003ec40000,0xbf7b00003f350000,0x3f0e00003ec40000,0xbe480000bf350000,0xbf5500003f6d0000
.quad 0xbf0e0000bf350000,0x3e4800003f6d0000,0x3f550000bf350000,0xbf7b00003ec40000,0xbf7b00003f350000,0x3f0e00003ec40000,0xbe480000bf350000,0xbf5500003f6d0000
.quad 0xbf0e0000bf350000,0x3e4800003f6d0000,0x3f550000bf350000,0xbf7b00003ec40000,0xbf7b00003f350000,0x3f0e00003ec40000,0xbe480000bf350000,0xbf5500003f6d0000
.quad 0xbf0e0000bf350000,0x3e4800003f6d0000,0x3f550000bf350000,0xbf7b00003ec40000,0xbf7b00003f350000,0x3f0e00003ec40000,0xbe480000bf350000,0xbf5500003f6d0000
.quad 0xbe4800003f800000,0x3f0e0000bf6d0000,0xbf7b000080000000,0x3f5500003ec40000,0xbf0e00003f800000,0x3f7b0000bec40000,0xbf55000080000000,0xbe4800003f6d0000
.quad 0xbe4800003f800000,0x3f0e0000bf6d0000,0xbf7b000080000000,0x3f5500003ec40000,0xbf0e00003f800000,0x3f7b0000bec40000,0xbf55000080000000,0xbe4800003f6d0000
.quad 0xbe4800003f800000,0x3f0e0000bf6d0000,0xbf7b000080000000,0x3f5500003ec40000,0xbf0e00003f800000,0x3f7b0000bec40000,0xbf55000080000000,0xbe4800003f6d0000
.quad 0xbe4800003f800000,0x3f0e0000bf6d0000,0xbf7b000080000000,0x3f5500003ec40000,0xbf0e00003f800000,0x3f7b0000bec40000,0xbf55000080000000,0xbe4800003f6d0000
.quad 0xbf5500003f350000,0x3f7b0000bec40000,0xbf0e0000bf350000,0x3e4800003f6d0000,0xbe480000bf350000,0xbf5500003f6d0000,0x3f7b0000bf350000,0xbf0e0000bec40000
.quad 0xbf5500003f350000,0x3f7b0000bec40000,0xbf0e0000bf350000,0x3e4800003f6d0000,0xbe480000bf350000,0xbf5500003f6d0000,0x3f7b0000bf350000,0xbf0e0000bec40000
.quad 0xbf5500003f350000,0x3f7b0000bec40000,0xbf0e0000bf350000,0x3e4800003f6d0000,0xbe480000bf350000,0xbf5500003f6d0000,0x3f7b0000bf350000,0xbf0e0000bec40000
.quad 0xbf5500003f350000,0x3f7b0000bec40000,0xbf0e0000bf350000,0x3e4800003f6d0000,0xbe480000bf350000,0xbf5500003f6d0000,0x3f7b0000bf350000,0xbf0e0000bec40000
.quad 0xbe4800003f350000,0x3f550000bec40000,0xbf7b00003f350000,0xbf0e00003f6d0000,0x3f550000bf350000,0x3f7b0000bf6d0000,0xbf0e00003f350000,0xbe4800003ec40000
.quad 0xbe4800003f350000,0x3f550000bec40000,0xbf7b00003f350000,0xbf0e00003f6d0000,0x3f550000bf350000,0x3f7b0000bf6d0000,0xbf0e00003f350000,0xbe4800003ec40000
.quad 0xbe4800003f350000,0x3f550000bec40000,0xbf7b00003f350000,0xbf0e00003f6d0000,0x3f550000bf350000,0x3f7b0000bf6d0000,0xbf0e00003f350000,0xbe4800003ec40000
.quad 0xbe4800003f350000,0x3f550000bec40000,0xbf7b00003f350000,0xbf0e00003f6d0000,0x3f550000bf350000,0x3f7b0000bf6d0000,0xbf0e00003f350000,0xbe4800003ec40000
.quad 0xbf5500003f800000,0x3e4800003ec40000,0xbf0e000080000000,0xbf7b00003f6d0000,0xbf7b00003f800000,0xbf5500003f6d0000,0xbe48000080000000,0xbf0e00003ec40000
.quad 0xbf5500003f800000,0x3e4800003ec40000,0xbf0e000080000000,0xbf7b00003f6d0000,0xbf7b00003f800000,0xbf5500003f6d0000,0xbe48000080000000,0xbf0e00003ec40000
.quad 0xbf5500003f800000,0x3e4800003ec40000,0xbf0e000080000000,0xbf7b00003f6d0000,0xbf7b00003f800000,0xbf5500003f6d0000,0xbe48000080000000,0xbf0e00003ec40000
.quad 0xbf5500003f800000,0x3e4800003ec40000,0xbf0e000080000000,0xbf7b00003f6d0000,0xbf7b00003f800000,0xbf5500003f6d0000,0xbe48000080000000,0xbf0e00003ec40000
.quad 0x3f7b0000bf350000,0x3f0e0000bf6d0000,0xbe4800003f350000,0x3f550000bec40000,0xbf0e00003f350000,0xbe4800003ec40000,0xbf5500003f350000,0xbf7b00003f6d0000
.quad 0x3f7b0000bf350000,0x3f0e0000bf6d0000,0xbe4800003f350000,0x3f550000bec40000,0xbf0e00003f350000,0xbe4800003ec40000,0xbf5500003f350000,0xbf7b00003f6d0000
.quad 0x3f7b0000bf350000,0x3f0e0000bf6d0000,0xbe4800003f350000,0x3f550000bec40000,0xbf0e00003f350000,0xbe4800003ec40000,0xbf5500003f350000,0xbf7b00003f6d0000
.quad 0x3f7b0000bf350000,0x3f0e0000bf6d0000,0xbe4800003f350000,0x3f550000bec40000,0xbf0e00003f350000,0xbe4800003ec40000,0xbf5500003f350000,0xbf7b00003f6d0000
.quad 0xbf0e000000000000,0xbf7b00003f6d0000,0x3f550000bf800000,0xbe480000bec40000,0x3e48000000000000,0x3f0e0000bec40000,0xbf7b00003f800000,0xbf5500003f6d0000
.quad 0xbf0e000000000000,0xbf7b00003f6d0000,0x3f550000bf800000,0xbe480000bec40000,0x3e48000000000000,0x3f0e0000bec40000,0xbf7b00003f800000,0xbf5500003f6d0000
.quad 0xbf0e000000000000,0xbf7b00003f6d0000,0x3f550000bf800000,0xbe480000bec40000,0x3e48000000000000,0x3f0e0000bec40000,0xbf7b00003f800000,0xbf5500003f6d0000
.quad 0xbf0e000000000000,0xbf7b00003f6d0000,0x3f550000bf800000,0xbe480000bec40000,0x3e48000000000000,0x3f0e0000bec40000,0xbf7b00003f800000,0xbf5500003f6d0000
.quad 0xbf8000003f80,0xbf8000003f80,0x800000008000,0x800000008000,0,0,0,0
.quad 0xbf8000003f80,0xbf8000003f80,0x800000008000,0x800000008000,0,0,0,0
.quad 0xbf8000003f80,0xbf8000003f80,0x800000008000,0x800000008000,0,0,0,0
.quad 0xbf8000003f80,0xbf8000003f80,0x800000008000,0x800000008000,0,0,0,0
.quad 0xbf8000003f80,0xbf8000003f80,0x800000008000,0x800000008000,0,0,0,0
.quad 0xbf8000003f80,0xbf8000003f80,0x800000008000,0x800000008000,0,0,0,0
.quad 0xbf8000003f80,0xbf8000003f80,0x800000008000,0x800000008000,0,0,0,0
.quad 0xbf8000003f80,0xbf8000003f80,0x800000008000,0x800000008000,0,0,0,0
.quad 0xbf8000003f80,0xbf8000003f80,0x800000008000,0x800000008000,0,0,0,0
.quad 0xbf8000003f80,0xbf8000003f80,0x800000008000,0x800000008000,0,0,0,0
.quad 0xbf8000003f80,0xbf8000003f80,0x800000008000,0x800000008000,0,0,0,0
.quad 0xbf8000003f80,0xbf8000003f80,0x800000008000,0x800000008000,0,0,0,0
.quad 0xbf8000003f80,0xbf8000003f80,0x800000008000,0x800000008000,0,0,0,0
.quad 0xbf8000003f80,0xbf8000003f80,0x800000008000,0x800000008000,0,0,0,0
.quad 0xbf8000003f80,0xbf8000003f80,0x800000008000,0x800000008000,0,0,0,0
.quad 0xbf8000003f80,0xbf8000003f80,0x800000008000,0x800000008000,0,0,0,0
.quad 0,0,0,0,0,0,0,0
.quad 0,0,0,0,0,0,0,0
.quad 0,0,0,0,0,0,0,0
.quad 0,0,0,0,0,0,0,0
.quad 0,0,0,0,0,0,0,0
.quad 0,0,0,0,0,0,0,0
.quad 0,0,0,0,0,0,0,0
.quad 0,0,0,0,0,0,0,0
.quad 0,0,0,0,0,0,0,0
.quad 0,0,0,0,0,0,0,0
.quad 0,0,0,0,0,0,0,0
.quad 0,0,0,0,0,0,0,0
.quad 0,0,0,0,0,0,0,0
.quad 0,0,0,0,0,0,0,0
.quad 0,0,0,0,0,0,0,0
.quad 0,0,0,0,0,0,0,0
.quad 0,0,0,0,0,0,0,0
.quad 0,0,0,0,0,0,0,0
.quad 0,0,0,0,0,0,0,0
.quad 0,0,0,0,0,0,0,0
.quad 0,0,0,0,0,0,0,0
.quad 0,0,0,0,0,0,0,0
.quad 0,0,0,0,0,0,0,0
.quad 0,0,0,0,0,0,0,0
.quad 0,0,0,0,0,0,0,0
.quad 0,0,0,0,0,0,0,0
.quad 0,0,0,0,0,0,0,0
.quad 0,0,0,0,0,0,0,0
.quad 0,0,0,0,0,0,0,0
.quad 0,0,0,0,0,0,0,0
.quad 0,0,0,0,0,0,0,0
.quad 0,0,0,0,0,0,0,0
.quad 0,0,0,0,0,0,0,0
.quad 0,0,0,0,0,0,0,0
.quad 0,0,0,0,0,0,0,0
.quad 0,0,0,0,0,0,0,0
.quad 0,0,0,0,0,0,0,0
.quad 0,0,0,0,0,0,0,0
.quad 0,0,0,0,0,0,0,0
.quad 0,0,0,0,0,0,0,0
.quad 0,0,0,0,0,0,0,0
.quad 0,0,0,0,0,0,0,0
.quad 0,0,0,0,0,0,0,0
.quad 0,0,0,0,0,0,0,0
.quad 0,0,0,0,0,0,0,0
.quad 0,0,0,0,0,0,0,0
.quad 0,0,0,0,0,0,0,0
.quad 0,0,0,0,0,0,0,0
.section .rodata,"a"
.p2align 6
.amdhsa_kernel concat_heads__spectral_fnet__spectral_fnet__prompt_kernel
  .amdhsa_next_free_vgpr 204
  .amdhsa_next_free_sgpr 72
  .amdhsa_accum_offset 204
  .amdhsa_group_segment_fixed_size 0
  .amdhsa_kernarg_size 104
  .amdhsa_user_sgpr_count 2
  .amdhsa_user_sgpr_kernarg_segment_ptr 1
  .amdhsa_system_sgpr_workgroup_id_x 1
.end_amdhsa_kernel
```
